```python
import torch

def _softmax(x, axis=-1):
    return torch.softmax(x, dim=axis)
def _gelu(x):
    return torch.nn.functional.gelu(x, approximate="tanh")
def _silu(x):
    return torch.nn.functional.silu(x)
def _sigmoid(x):
    return torch.sigmoid(x)
def _layernorm(x, axis=-1, eps=1e-5):
    m = x.mean(dim=axis, keepdim=True)
    v = x.var(dim=axis, keepdim=True, unbiased=False)
    return (x - m) / torch.sqrt(v + eps)
def _scatter_add(tgt, idx, src, axis=0):
    return tgt.clone().index_add_(axis, idx, src)
def _segment_sum(src, seg, n):
    out = torch.zeros((n,) + src.shape[1:], dtype=src.dtype)
    return out.index_add_(0, seg, src)
def _pad(x, pw):
    flat = tuple(v for pair in reversed(pw) for v in pair)
    return torch.nn.functional.pad(x, flat)

kernel_name = 'parallel_sum__gqa_block_cached__dense_activation_gelu__decode'

def setup_inputs():

    _w = (lambda a: (lambda t: t.to(torch.bfloat16) if t.is_floating_point() else t)(torch.as_tensor(a)))
    def _A_setup():
        B, Sq, D = 1, 1, 448
        Hq, Hkv, Sk, Dh = 16, 8, 65536, 256
        assert Hq % Hkv == 0, (Hq, Hkv)
        return {
            "x": _w((lambda *s: torch.randn(*s, dtype=torch.bfloat16) * 0.05)(B, Sq, D)),
            "k_cache": _w((lambda *s: torch.randn(*s, dtype=torch.bfloat16) * 3.2)(B, Hkv, Sk, Dh)),
            "v_cache": _w((lambda *s: torch.randn(*s, dtype=torch.bfloat16) * 1.6)(B, Hkv, Sk, Dh)),
            "wq": _w((lambda *s: torch.randn(*s, dtype=torch.bfloat16) * 3.2)(D, Hq * Dh) * (D ** -0.5)),
            "wo": _w((lambda *s: torch.randn(*s, dtype=torch.bfloat16) * 1.6)(Hq * Dh, D) * ((Hq * Dh) ** -0.5)),
        }
    _A_in = _A_setup()

    def _B_setup():
        B, S, D, F = 1, 1, 448, 1792
        return {
            "x": _w((lambda *s: torch.randn(*s, dtype=torch.bfloat16) * 0.05)(B, S, D)),
            "w1": _w((lambda *s: torch.randn(*s, dtype=torch.bfloat16) * 1.6)(D, F) * (D ** -0.5)),
            "b1": _w((lambda *s: torch.randn(*s, dtype=torch.bfloat16) * 1.6)(F) * 0.01),
            "w2": _w((lambda *s: torch.randn(*s, dtype=torch.bfloat16) * 1.6)(F, D) * (F ** -0.5)),
            "b2": _w((lambda *s: torch.randn(*s, dtype=torch.bfloat16) * 1.6)(D) * 0.01),
        }
    _B_in = _B_setup()

    return {
        "A_x": _A_in["x"],
        "A_k_cache": _A_in["k_cache"],
        "A_v_cache": _A_in["v_cache"],
        "A_wq": _A_in["wq"],
        "A_wo": _A_in["wo"],
        "B_x": _B_in["x"],
        "B_w1": _B_in["w1"],
        "B_b1": _B_in["b1"],
        "B_w2": _B_in["w2"],
        "B_b2": _B_in["b2"],
    }

def reference(A_x, A_k_cache, A_v_cache, A_wq, A_wo, B_x, B_w1, B_b1, B_w2, B_b2):
    def _A_ref(x, k_cache, v_cache, wq, wo):
        B, Sq, D = x.shape
        Hq, Dh = 16, 256
        Hkv = k_cache.shape[1]
        rep = Hq // Hkv
        q = (lambda x, *d: x.permute(*d))((x @ wq).reshape(B, Sq, Hq, Dh), 0, 2, 1, 3)
        k = (lambda x, n, axis: torch.repeat_interleave(x, n, dim=axis))(k_cache, rep, axis=1)
        v = (lambda x, n, axis: torch.repeat_interleave(x, n, dim=axis))(v_cache, rep, axis=1)
        scores = torch.einsum("bhqd,bhkd->bhqk", q, k) * (Dh ** -0.5)
        p = _softmax(scores, axis=-1)
        o = torch.einsum("bhqk,bhkd->bhqd", p, v)
        return (lambda x, *d: x.permute(*d))(o, 0, 2, 1, 3).reshape(B, Sq, Hq * Dh) @ wo

    def _B_ref(x, w1, b1, w2, b2):
        h = torch.einsum("bsd,df->bsf", x, w1) + b1
        h = _gelu(h)
        return torch.einsum("bsf,fd->bsd", h, w2) + b2

    x = A_x
    xn = _layernorm(x, axis=-1)
    return x + _A_ref(xn, A_k_cache, A_v_cache, A_wq, A_wo) + _B_ref(xn, B_w1, B_b1, B_w2, B_b2)
```

```asm
; @launch grid=(256,1,1) block=(320,1,1) lds=157824
.amdgcn_target "amdgcn-amd-amdhsa--gfx950"
.text
    .globl parallel_sum__gqa_block_cached__dense_activation_gelu__decode_kernel
    .p2align 8
    .type parallel_sum__gqa_block_cached__dense_activation_gelu__decode_kernel,@function
parallel_sum__gqa_block_cached__dense_activation_gelu__decode_kernel:
    s_cmp_ge_u32 s2, 256
    s_cbranch_scc1 L_done
    s_load_dwordx16 s[16:31], s[0:1], 0
    s_load_dwordx8 s[32:39], s[0:1], 64
    s_load_dwordx2 s[40:41], s[0:1], 96
    v_lshrrev_b32 v1, 6, v0
    v_and_b32 v2, 63, v0
    s_nop 0
    v_readfirstlane_b32 s3, v1
    s_cmp_eq_u32 s3, 4
    s_cbranch_scc1 L_aux
    v_lshrrev_b32 v3, 5, v2
    v_and_b32 v4, 31, v2
    v_lshlrev_b32 v5, 2, v3
    v_xor_b32 v4, v4, v5
    v_lshlrev_b32 v4, 4, v4
    v_lshl_add_u32 v4, v3, 9, v4
    v_xor_b32 v8, 0x0, v4
    v_xor_b32 v9, 0x80, v4
    v_xor_b32 v10, 0x10, v4
    v_xor_b32 v11, 0x90, v4
    v_xor_b32 v12, 0x1020, v4
    v_xor_b32 v13, 0x10a0, v4
    v_xor_b32 v14, 0x1030, v4
    v_xor_b32 v15, 0x10b0, v4
    s_lshl_b32 s60, s3, 15
    s_lshr_b32 s4, s2, 5
    s_lshl_b32 s78, s4, 25
    s_lshl_b32 s5, s3, 13
    s_add_u32 s78, s78, s5
    s_mul_i32 s62, s4, 12
    s_and_b32 s5, s2, 31
    s_mul_i32 s79, s5, 0
    s_lshl_b32 s61, s5, 17
    s_add_u32 s61, s61, s78
    s_mov_b32 s68, s62
    s_waitcnt lgkmcnt(0)
    s_mov_b32 s44, s18
    s_mov_b32 s45, s19
    s_mov_b32 s46, 0x10000000
    s_mov_b32 s47, 0x20000
    s_bfe_u32 s4, s62, 0x30002
    s_lshl_b32 s4, s4, 22
    s_add_u32 s63, s61, s4
    s_add_u32 s4, s62, s79
    s_and_b32 s4, s4, 3
    s_lshl_b32 s4, s4, 15
    s_add_u32 s63, s63, s4
    s_add_u32 s62, s62, 1
    s_add_u32 m0, s60, 0
    s_nop 0
    buffer_load_dwordx4 v8, s[44:47], s63 offen offset:0 nt lds
    s_add_u32 m0, s60, 0
    s_nop 0
    buffer_load_dwordx4 v10, s[44:47], s63 offen offset:2048 nt lds
    s_add_u32 m0, s60, 4096
    s_nop 0
    buffer_load_dwordx4 v12, s[44:47], s63 offen offset:0 nt lds
    s_add_u32 m0, s60, 4096
    s_nop 0
    buffer_load_dwordx4 v14, s[44:47], s63 offen offset:2048 nt lds
    s_add_u32 m0, s60, 0
    s_nop 0
    buffer_load_dwordx4 v9, s[44:47], s63 offen offset:1024 nt lds
    s_add_u32 m0, s60, 0
    s_nop 0
    buffer_load_dwordx4 v11, s[44:47], s63 offen offset:3072 nt lds
    s_add_u32 m0, s60, 4096
    s_nop 0
    buffer_load_dwordx4 v13, s[44:47], s63 offen offset:1024 nt lds
    s_add_u32 m0, s60, 4096
    s_nop 0
    buffer_load_dwordx4 v15, s[44:47], s63 offen offset:3072 nt lds
    s_mov_b32 s48, s20
    s_mov_b32 s49, s21
    s_mov_b32 s50, 0x10000000
    s_mov_b32 s51, 0x20000
    v_lshlrev_b32 v16, 4, v2
    v_add_u32 v17, 0x1000, v16
    v_lshrrev_b32 v3, 4, v2
    v_and_b32 v4, 15, v2
    v_and_b32 v5, 3, v4
    v_lshlrev_b32 v5, 2, v5
    v_lshrrev_b32 v6, 2, v4
    v_add_u32 v5, v5, v6
    v_xor_b32 v6, v3, v4
    v_lshlrev_b32 v6, 4, v6
    v_lshl_add_u32 v6, v5, 9, v6
    v_add_u32 v6, s60, v6
    v_xor_b32 v18, 0, v6
    v_xor_b32 v19, 64, v6
    v_xor_b32 v20, 128, v6
    v_xor_b32 v21, 192, v6
    v_lshlrev_b32 v6, 4, v4
    v_lshl_add_u32 v6, v3, 9, v6
    v_add_u32 v22, s60, v6
    s_lshl_b32 s64, s3, 11
    s_add_u32 s64, s64, 131072
    v_lshrrev_b32 v5, 3, v4
    v_lshlrev_b32 v6, 5, v5
    v_lshl_add_u32 v6, v3, 3, v6
    v_add_u32 v23, s64, v6
    v_lshlrev_b32 v7, 9, v5
    v_lshl_add_u32 v7, v3, 4, v7
    v_add_u32 v7, 156672, v7
    v_and_b32 v5, 1, v4
    v_lshlrev_b32 v5, 4, v5
    v_mov_b32 v6, 0xffff
    v_lshlrev_b32 v6, v5, v6
    v_bfe_u32 v5, v4, 1, 2
    v_cmp_eq_u32 vcc, 0, v5
    s_nop 1
    v_cndmask_b32 v24, 0, v6, vcc
    v_cmp_eq_u32 vcc, 1, v5
    s_nop 1
    v_cndmask_b32 v25, 0, v6, vcc
    v_cmp_eq_u32 vcc, 2, v5
    s_nop 1
    v_cndmask_b32 v26, 0, v6, vcc
    v_cmp_eq_u32 vcc, 3, v5
    s_nop 1
    v_cndmask_b32 v27, 0, v6, vcc
    v_mov_b32 v28, 0xff800000
    v_subrev_u32 v31, s60, v22
    v_add_u32 v1, 0x1000, v31
    s_bfe_u32 s4, s62, 0x30002
    s_lshl_b32 s4, s4, 22
    s_add_u32 s63, s61, s4
    s_add_u32 s4, s62, s79
    s_and_b32 s4, s4, 3
    s_lshl_b32 s4, s4, 15
    s_add_u32 s63, s63, s4
    s_add_u32 s62, s62, 1
    s_add_u32 m0, s60, 8192
    s_waitcnt vmcnt(4)
    buffer_load_dwordx4 v8, s[44:47], s63 offen offset:0 nt lds
    s_add_u32 m0, s60, 8192
    s_waitcnt vmcnt(4)
    buffer_load_dwordx4 v10, s[44:47], s63 offen offset:2048 nt lds
    s_add_u32 m0, s60, 12288
    s_waitcnt vmcnt(4)
    buffer_load_dwordx4 v12, s[44:47], s63 offen offset:0 nt lds
    s_add_u32 m0, s60, 12288
    s_waitcnt vmcnt(5)
    buffer_load_dwordx4 v14, s[44:47], s63 offen offset:2048 nt lds
    s_add_u32 m0, s60, 8192
    s_waitcnt vmcnt(4)
    buffer_load_dwordx4 v9, s[44:47], s63 offen offset:1024 nt lds
    s_add_u32 m0, s60, 8192
    s_waitcnt vmcnt(4)
    buffer_load_dwordx4 v11, s[44:47], s63 offen offset:3072 nt lds
    s_add_u32 m0, s60, 12288
    s_waitcnt vmcnt(4)
    buffer_load_dwordx4 v13, s[44:47], s63 offen offset:1024 nt lds
    s_add_u32 m0, s60, 12288
    s_waitcnt vmcnt(5)
    buffer_load_dwordx4 v15, s[44:47], s63 offen offset:3072 nt lds
    s_bfe_u32 s4, s62, 0x30002
    s_lshl_b32 s4, s4, 22
    s_add_u32 s63, s61, s4
    s_add_u32 s4, s62, s79
    s_and_b32 s4, s4, 3
    s_lshl_b32 s4, s4, 15
    s_add_u32 s63, s63, s4
    s_add_u32 s62, s62, 1
    s_add_u32 m0, s60, 16384
    s_waitcnt vmcnt(4)
    buffer_load_dwordx4 v8, s[44:47], s63 offen offset:0 nt lds
    s_add_u32 m0, s60, 16384
    s_waitcnt vmcnt(4)
    buffer_load_dwordx4 v10, s[44:47], s63 offen offset:2048 nt lds
    s_add_u32 m0, s60, 20480
    s_waitcnt vmcnt(4)
    buffer_load_dwordx4 v12, s[44:47], s63 offen offset:0 nt lds
    s_add_u32 m0, s60, 20480
    s_waitcnt vmcnt(5)
    buffer_load_dwordx4 v14, s[44:47], s63 offen offset:2048 nt lds
    s_add_u32 m0, s60, 16384
    s_waitcnt vmcnt(4)
    buffer_load_dwordx4 v9, s[44:47], s63 offen offset:1024 nt lds
    s_add_u32 m0, s60, 16384
    s_waitcnt vmcnt(4)
    buffer_load_dwordx4 v11, s[44:47], s63 offen offset:3072 nt lds
    s_add_u32 m0, s60, 20480
    s_waitcnt vmcnt(4)
    buffer_load_dwordx4 v13, s[44:47], s63 offen offset:1024 nt lds
    s_add_u32 m0, s60, 20480
    s_waitcnt vmcnt(5)
    buffer_load_dwordx4 v15, s[44:47], s63 offen offset:3072 nt lds
    s_bfe_u32 s4, s68, 0x30002
    s_lshl_b32 s4, s4, 22
    s_add_u32 s63, s61, s4
    s_add_u32 s4, s68, s79
    s_and_b32 s4, s4, 3
    s_lshl_b32 s4, s4, 15
    s_add_u32 s63, s63, s4
    s_waitcnt vmcnt(4)
    buffer_load_dwordx4 v[104:107], v31, s[48:51], s63 offen offset:0 nt
    s_waitcnt vmcnt(4)
    buffer_load_dwordx4 v[112:115], v31, s[48:51], s63 offen offset:2048 nt
    s_waitcnt vmcnt(4)
    buffer_load_dwordx4 v[120:123], v1, s[48:51], s63 offen offset:0 nt
    s_waitcnt vmcnt(4)
    buffer_load_dwordx4 v[128:131], v1, s[48:51], s63 offen offset:2048 nt
    s_waitcnt vmcnt(4)
    buffer_load_dwordx4 v[108:111], v31, s[48:51], s63 offen offset:256 nt
    s_waitcnt vmcnt(5)
    buffer_load_dwordx4 v[116:119], v31, s[48:51], s63 offen offset:2304 nt
    s_waitcnt vmcnt(4)
    buffer_load_dwordx4 v[124:127], v1, s[48:51], s63 offen offset:256 nt
    s_waitcnt vmcnt(5)
    buffer_load_dwordx4 v[132:135], v1, s[48:51], s63 offen offset:2304 nt
    s_add_u32 s68, s68, 1
    s_bfe_u32 s4, s68, 0x30002
    s_lshl_b32 s4, s4, 22
    s_add_u32 s63, s61, s4
    s_add_u32 s4, s68, s79
    s_and_b32 s4, s4, 3
    s_lshl_b32 s4, s4, 15
    s_add_u32 s63, s63, s4
    s_waitcnt vmcnt(4)
    buffer_load_dwordx4 v[136:139], v31, s[48:51], s63 offen offset:0 nt
    s_waitcnt vmcnt(4)
    buffer_load_dwordx4 v[144:147], v31, s[48:51], s63 offen offset:2048 nt
    s_waitcnt vmcnt(4)
    buffer_load_dwordx4 v[152:155], v1, s[48:51], s63 offen offset:0 nt
    s_waitcnt vmcnt(4)
    buffer_load_dwordx4 v[160:163], v1, s[48:51], s63 offen offset:2048 nt
    s_waitcnt vmcnt(4)
    buffer_load_dwordx4 v[140:143], v31, s[48:51], s63 offen offset:256 nt
    s_waitcnt vmcnt(5)
    buffer_load_dwordx4 v[148:151], v31, s[48:51], s63 offen offset:2304 nt
    s_waitcnt vmcnt(4)
    buffer_load_dwordx4 v[156:159], v1, s[48:51], s63 offen offset:256 nt
    s_waitcnt vmcnt(5)
    buffer_load_dwordx4 v[164:167], v1, s[48:51], s63 offen offset:2304 nt
    s_add_u32 s68, s68, 1
    s_bfe_u32 s4, s68, 0x30002
    s_lshl_b32 s4, s4, 22
    s_add_u32 s63, s61, s4
    s_add_u32 s4, s68, s79
    s_and_b32 s4, s4, 3
    s_lshl_b32 s4, s4, 15
    s_add_u32 s63, s63, s4
    s_waitcnt vmcnt(4)
    buffer_load_dwordx4 v[168:171], v31, s[48:51], s63 offen offset:0 nt
    s_waitcnt vmcnt(4)
    buffer_load_dwordx4 v[176:179], v31, s[48:51], s63 offen offset:2048 nt
    s_waitcnt vmcnt(4)
    buffer_load_dwordx4 v[184:187], v1, s[48:51], s63 offen offset:0 nt
    s_waitcnt vmcnt(4)
    buffer_load_dwordx4 v[192:195], v1, s[48:51], s63 offen offset:2048 nt
    s_waitcnt vmcnt(4)
    buffer_load_dwordx4 v[172:175], v31, s[48:51], s63 offen offset:256 nt
    s_waitcnt vmcnt(5)
    buffer_load_dwordx4 v[180:183], v31, s[48:51], s63 offen offset:2304 nt
    s_waitcnt vmcnt(4)
    buffer_load_dwordx4 v[188:191], v1, s[48:51], s63 offen offset:256 nt
    s_waitcnt vmcnt(5)
    buffer_load_dwordx4 v[196:199], v1, s[48:51], s63 offen offset:2304 nt
    s_add_u32 s68, s68, 1
    s_bfe_u32 s4, s68, 0x30002
    s_lshl_b32 s4, s4, 22
    s_add_u32 s63, s61, s4
    s_add_u32 s4, s68, s79
    s_and_b32 s4, s4, 3
    s_lshl_b32 s4, s4, 15
    s_add_u32 s63, s63, s4
    s_waitcnt vmcnt(4)
    buffer_load_dwordx4 v[200:203], v31, s[48:51], s63 offen offset:0 nt
    s_waitcnt vmcnt(4)
    buffer_load_dwordx4 v[208:211], v31, s[48:51], s63 offen offset:2048 nt
    s_waitcnt vmcnt(4)
    buffer_load_dwordx4 v[216:219], v1, s[48:51], s63 offen offset:0 nt
    s_waitcnt vmcnt(4)
    buffer_load_dwordx4 v[224:227], v1, s[48:51], s63 offen offset:2048 nt
    s_waitcnt vmcnt(4)
    buffer_load_dwordx4 v[204:207], v31, s[48:51], s63 offen offset:256 nt
    s_waitcnt vmcnt(5)
    buffer_load_dwordx4 v[212:215], v31, s[48:51], s63 offen offset:2304 nt
    s_waitcnt vmcnt(4)
    buffer_load_dwordx4 v[220:223], v1, s[48:51], s63 offen offset:256 nt
    s_waitcnt vmcnt(5)
    buffer_load_dwordx4 v[228:231], v1, s[48:51], s63 offen offset:2304 nt
    s_add_u32 s68, s68, 25
    s_mov_b32 s56, s40
    s_mov_b32 s57, s41
    s_mov_b32 s58, 0x40000000
    s_mov_b32 s59, 0x20000
    s_barrier
    ds_read_b128 v[32:35], v7 offset:0
    ds_read_b128 v[36:39], v7 offset:64
    ds_read_b128 v[40:43], v7 offset:128
    ds_read_b128 v[44:47], v7 offset:192
    ds_read_b128 v[48:51], v7 offset:256
    ds_read_b128 v[52:55], v7 offset:320
    ds_read_b128 v[56:59], v7 offset:384
    ds_read_b128 v[60:63], v7 offset:448
    s_mov_b32 s64, 7
L_kloop1:
    s_bfe_u32 s4, s62, 0x30002
    s_lshl_b32 s4, s4, 22
    s_add_u32 s63, s61, s4
    s_add_u32 s4, s62, s79
    s_and_b32 s4, s4, 3
    s_lshl_b32 s4, s4, 15
    s_add_u32 s63, s63, s4
    s_add_u32 s62, s62, 1
    s_add_u32 m0, s60, 24576
    s_waitcnt vmcnt(4)
    buffer_load_dwordx4 v8, s[44:47], s63 offen offset:0 nt lds
    s_waitcnt vmcnt(16)
    ds_read_b128 v[64:67], v18 offset:0
    ds_read_b128 v[68:71], v19 offset:0
    ds_read_b128 v[72:75], v20 offset:0
    ds_read_b128 v[76:79], v21 offset:0
    ds_read_b128 v[80:83], v18 offset:256
    ds_read_b128 v[84:87], v19 offset:256
    ds_read_b128 v[88:91], v20 offset:256
    ds_read_b128 v[92:95], v21 offset:256
    s_add_u32 m0, s60, 24576
    s_waitcnt vmcnt(4)
    buffer_load_dwordx4 v10, s[44:47], s63 offen offset:2048 nt lds
    s_waitcnt lgkmcnt(0)
    v_mfma_f32_16x16x32_bf16 v[96:99], v[64:67], v[32:35], 0
    v_mfma_f32_16x16x32_bf16 v[96:99], v[68:71], v[36:39], v[96:99]
    v_mfma_f32_16x16x32_bf16 v[96:99], v[72:75], v[40:43], v[96:99]
    v_mfma_f32_16x16x32_bf16 v[96:99], v[76:79], v[44:47], v[96:99]
    s_add_u32 m0, s60, 28672
    s_waitcnt vmcnt(4)
    buffer_load_dwordx4 v12, s[44:47], s63 offen offset:0 nt lds
    v_mfma_f32_16x16x32_bf16 v[96:99], v[80:83], v[48:51], v[96:99]
    v_mfma_f32_16x16x32_bf16 v[96:99], v[84:87], v[52:55], v[96:99]
    v_mfma_f32_16x16x32_bf16 v[96:99], v[88:91], v[56:59], v[96:99]
    v_mfma_f32_16x16x32_bf16 v[96:99], v[92:95], v[60:63], v[96:99]
    s_add_u32 m0, s60, 28672
    s_waitcnt vmcnt(5)
    buffer_load_dwordx4 v14, s[44:47], s63 offen offset:2048 nt lds
    s_nop 4
    v_cvt_pk_bf16_f32 v100, v96, v97
    v_cvt_pk_bf16_f32 v101, v98, v99
    v_max3_f32 v28, v28, v96, v97
    v_max3_f32 v28, v28, v98, v99
    ds_write_b64 v23, v[100:101] offset:0
    s_add_u32 m0, s60, 24576
    s_waitcnt vmcnt(4)
    buffer_load_dwordx4 v9, s[44:47], s63 offen offset:1024 nt lds
    s_add_u32 m0, s60, 24576
    s_waitcnt vmcnt(4)
    buffer_load_dwordx4 v11, s[44:47], s63 offen offset:3072 nt lds
    s_add_u32 m0, s60, 28672
    s_waitcnt vmcnt(4)
    buffer_load_dwordx4 v13, s[44:47], s63 offen offset:1024 nt lds
    s_add_u32 m0, s60, 28672
    s_waitcnt vmcnt(5)
    buffer_load_dwordx4 v15, s[44:47], s63 offen offset:3072 nt lds
    s_bfe_u32 s4, s62, 0x30002
    s_lshl_b32 s4, s4, 22
    s_add_u32 s63, s61, s4
    s_add_u32 s4, s62, s79
    s_and_b32 s4, s4, 3
    s_lshl_b32 s4, s4, 15
    s_add_u32 s63, s63, s4
    s_add_u32 s62, s62, 1
    s_add_u32 m0, s60, 0
    s_waitcnt vmcnt(4)
    buffer_load_dwordx4 v8, s[44:47], s63 offen offset:0 nt lds
    s_waitcnt vmcnt(16)
    ds_read_b128 v[64:67], v18 offset:8192
    ds_read_b128 v[68:71], v19 offset:8192
    ds_read_b128 v[72:75], v20 offset:8192
    ds_read_b128 v[76:79], v21 offset:8192
    ds_read_b128 v[80:83], v18 offset:8448
    ds_read_b128 v[84:87], v19 offset:8448
    ds_read_b128 v[88:91], v20 offset:8448
    ds_read_b128 v[92:95], v21 offset:8448
    s_add_u32 m0, s60, 0
    s_waitcnt vmcnt(4)
    buffer_load_dwordx4 v10, s[44:47], s63 offen offset:2048 nt lds
    s_waitcnt lgkmcnt(0)
    v_mfma_f32_16x16x32_bf16 v[96:99], v[64:67], v[32:35], 0
    v_mfma_f32_16x16x32_bf16 v[96:99], v[68:71], v[36:39], v[96:99]
    v_mfma_f32_16x16x32_bf16 v[96:99], v[72:75], v[40:43], v[96:99]
    v_mfma_f32_16x16x32_bf16 v[96:99], v[76:79], v[44:47], v[96:99]
    s_add_u32 m0, s60, 4096
    s_waitcnt vmcnt(4)
    buffer_load_dwordx4 v12, s[44:47], s63 offen offset:0 nt lds
    v_mfma_f32_16x16x32_bf16 v[96:99], v[80:83], v[48:51], v[96:99]
    v_mfma_f32_16x16x32_bf16 v[96:99], v[84:87], v[52:55], v[96:99]
    v_mfma_f32_16x16x32_bf16 v[96:99], v[88:91], v[56:59], v[96:99]
    v_mfma_f32_16x16x32_bf16 v[96:99], v[92:95], v[60:63], v[96:99]
    s_add_u32 m0, s60, 4096
    s_waitcnt vmcnt(5)
    buffer_load_dwordx4 v14, s[44:47], s63 offen offset:2048 nt lds
    s_nop 4
    v_cvt_pk_bf16_f32 v100, v96, v97
    v_cvt_pk_bf16_f32 v101, v98, v99
    v_max3_f32 v28, v28, v96, v97
    v_max3_f32 v28, v28, v98, v99
    ds_write_b64 v23, v[100:101] offset:64
    s_add_u32 m0, s60, 0
    s_waitcnt vmcnt(4)
    buffer_load_dwordx4 v9, s[44:47], s63 offen offset:1024 nt lds
    s_add_u32 m0, s60, 0
    s_waitcnt vmcnt(4)
    buffer_load_dwordx4 v11, s[44:47], s63 offen offset:3072 nt lds
    s_add_u32 m0, s60, 4096
    s_waitcnt vmcnt(4)
    buffer_load_dwordx4 v13, s[44:47], s63 offen offset:1024 nt lds
    s_add_u32 m0, s60, 4096
    s_waitcnt vmcnt(5)
    buffer_load_dwordx4 v15, s[44:47], s63 offen offset:3072 nt lds
    s_bfe_u32 s4, s62, 0x30002
    s_lshl_b32 s4, s4, 22
    s_add_u32 s63, s61, s4
    s_add_u32 s4, s62, s79
    s_and_b32 s4, s4, 3
    s_lshl_b32 s4, s4, 15
    s_add_u32 s63, s63, s4
    s_add_u32 s62, s62, 1
    s_add_u32 m0, s60, 8192
    s_waitcnt vmcnt(4)
    buffer_load_dwordx4 v8, s[44:47], s63 offen offset:0 nt lds
    s_waitcnt vmcnt(16)
    ds_read_b128 v[64:67], v18 offset:16384
    ds_read_b128 v[68:71], v19 offset:16384
    ds_read_b128 v[72:75], v20 offset:16384
    ds_read_b128 v[76:79], v21 offset:16384
    ds_read_b128 v[80:83], v18 offset:16640
    ds_read_b128 v[84:87], v19 offset:16640
    ds_read_b128 v[88:91], v20 offset:16640
    ds_read_b128 v[92:95], v21 offset:16640
    s_add_u32 m0, s60, 8192
    s_waitcnt vmcnt(4)
    buffer_load_dwordx4 v10, s[44:47], s63 offen offset:2048 nt lds
    s_waitcnt lgkmcnt(0)
    v_mfma_f32_16x16x32_bf16 v[96:99], v[64:67], v[32:35], 0
    v_mfma_f32_16x16x32_bf16 v[96:99], v[68:71], v[36:39], v[96:99]
    v_mfma_f32_16x16x32_bf16 v[96:99], v[72:75], v[40:43], v[96:99]
    v_mfma_f32_16x16x32_bf16 v[96:99], v[76:79], v[44:47], v[96:99]
    s_add_u32 m0, s60, 12288
    s_waitcnt vmcnt(4)
    buffer_load_dwordx4 v12, s[44:47], s63 offen offset:0 nt lds
    v_mfma_f32_16x16x32_bf16 v[96:99], v[80:83], v[48:51], v[96:99]
    v_mfma_f32_16x16x32_bf16 v[96:99], v[84:87], v[52:55], v[96:99]
    v_mfma_f32_16x16x32_bf16 v[96:99], v[88:91], v[56:59], v[96:99]
    v_mfma_f32_16x16x32_bf16 v[96:99], v[92:95], v[60:63], v[96:99]
    s_add_u32 m0, s60, 12288
    s_waitcnt vmcnt(5)
    buffer_load_dwordx4 v14, s[44:47], s63 offen offset:2048 nt lds
    s_nop 4
    v_cvt_pk_bf16_f32 v100, v96, v97
    v_cvt_pk_bf16_f32 v101, v98, v99
    v_max3_f32 v28, v28, v96, v97
    v_max3_f32 v28, v28, v98, v99
    ds_write_b64 v23, v[100:101] offset:128
    s_add_u32 m0, s60, 8192
    s_waitcnt vmcnt(4)
    buffer_load_dwordx4 v9, s[44:47], s63 offen offset:1024 nt lds
    s_add_u32 m0, s60, 8192
    s_waitcnt vmcnt(4)
    buffer_load_dwordx4 v11, s[44:47], s63 offen offset:3072 nt lds
    s_add_u32 m0, s60, 12288
    s_waitcnt vmcnt(4)
    buffer_load_dwordx4 v13, s[44:47], s63 offen offset:1024 nt lds
    s_add_u32 m0, s60, 12288
    s_waitcnt vmcnt(5)
    buffer_load_dwordx4 v15, s[44:47], s63 offen offset:3072 nt lds
    s_bfe_u32 s4, s62, 0x30002
    s_lshl_b32 s4, s4, 22
    s_add_u32 s63, s61, s4
    s_add_u32 s4, s62, s79
    s_and_b32 s4, s4, 3
    s_lshl_b32 s4, s4, 15
    s_add_u32 s63, s63, s4
    s_add_u32 s62, s62, 1
    s_add_u32 m0, s60, 16384
    s_waitcnt vmcnt(4)
    buffer_load_dwordx4 v8, s[44:47], s63 offen offset:0 nt lds
    s_waitcnt vmcnt(16)
    ds_read_b128 v[64:67], v18 offset:24576
    ds_read_b128 v[68:71], v19 offset:24576
    ds_read_b128 v[72:75], v20 offset:24576
    ds_read_b128 v[76:79], v21 offset:24576
    ds_read_b128 v[80:83], v18 offset:24832
    ds_read_b128 v[84:87], v19 offset:24832
    ds_read_b128 v[88:91], v20 offset:24832
    ds_read_b128 v[92:95], v21 offset:24832
    s_add_u32 m0, s60, 16384
    s_waitcnt vmcnt(4)
    buffer_load_dwordx4 v10, s[44:47], s63 offen offset:2048 nt lds
    s_waitcnt lgkmcnt(0)
    v_mfma_f32_16x16x32_bf16 v[96:99], v[64:67], v[32:35], 0
    v_mfma_f32_16x16x32_bf16 v[96:99], v[68:71], v[36:39], v[96:99]
    v_mfma_f32_16x16x32_bf16 v[96:99], v[72:75], v[40:43], v[96:99]
    v_mfma_f32_16x16x32_bf16 v[96:99], v[76:79], v[44:47], v[96:99]
    s_add_u32 m0, s60, 20480
    s_waitcnt vmcnt(4)
    buffer_load_dwordx4 v12, s[44:47], s63 offen offset:0 nt lds
    v_mfma_f32_16x16x32_bf16 v[96:99], v[80:83], v[48:51], v[96:99]
    v_mfma_f32_16x16x32_bf16 v[96:99], v[84:87], v[52:55], v[96:99]
    v_mfma_f32_16x16x32_bf16 v[96:99], v[88:91], v[56:59], v[96:99]
    v_mfma_f32_16x16x32_bf16 v[96:99], v[92:95], v[60:63], v[96:99]
    s_add_u32 m0, s60, 20480
    s_waitcnt vmcnt(5)
    buffer_load_dwordx4 v14, s[44:47], s63 offen offset:2048 nt lds
    s_nop 4
    v_cvt_pk_bf16_f32 v100, v96, v97
    v_cvt_pk_bf16_f32 v101, v98, v99
    v_max3_f32 v28, v28, v96, v97
    v_max3_f32 v28, v28, v98, v99
    ds_write_b64 v23, v[100:101] offset:192
    s_add_u32 m0, s60, 16384
    s_waitcnt vmcnt(4)
    buffer_load_dwordx4 v9, s[44:47], s63 offen offset:1024 nt lds
    s_add_u32 m0, s60, 16384
    s_waitcnt vmcnt(4)
    buffer_load_dwordx4 v11, s[44:47], s63 offen offset:3072 nt lds
    s_add_u32 m0, s60, 20480
    s_waitcnt vmcnt(4)
    buffer_load_dwordx4 v13, s[44:47], s63 offen offset:1024 nt lds
    s_add_u32 m0, s60, 20480
    s_waitcnt vmcnt(5)
    buffer_load_dwordx4 v15, s[44:47], s63 offen offset:3072 nt lds
    v_add_u32 v23, 256, v23
    s_sub_u32 s64, s64, 1
    s_cmp_lg_u32 s64, 0
    s_cbranch_scc1 L_kloop1
    s_bfe_u32 s4, s62, 0x30002
    s_lshl_b32 s4, s4, 22
    s_add_u32 s63, s61, s4
    s_add_u32 s4, s62, s79
    s_and_b32 s4, s4, 3
    s_lshl_b32 s4, s4, 15
    s_add_u32 s63, s63, s4
    s_add_u32 s62, s62, 1
    s_add_u32 m0, s60, 24576
    s_waitcnt vmcnt(4)
    buffer_load_dwordx4 v8, s[44:47], s63 offen offset:0 nt lds
    s_waitcnt vmcnt(16)
    ds_read_b128 v[64:67], v18 offset:0
    ds_read_b128 v[68:71], v19 offset:0
    ds_read_b128 v[72:75], v20 offset:0
    ds_read_b128 v[76:79], v21 offset:0
    ds_read_b128 v[80:83], v18 offset:256
    ds_read_b128 v[84:87], v19 offset:256
    ds_read_b128 v[88:91], v20 offset:256
    ds_read_b128 v[92:95], v21 offset:256
    s_add_u32 m0, s60, 24576
    s_waitcnt vmcnt(4)
    buffer_load_dwordx4 v10, s[44:47], s63 offen offset:2048 nt lds
    s_waitcnt lgkmcnt(0)
    v_mfma_f32_16x16x32_bf16 v[96:99], v[64:67], v[32:35], 0
    v_mfma_f32_16x16x32_bf16 v[96:99], v[68:71], v[36:39], v[96:99]
    v_mfma_f32_16x16x32_bf16 v[96:99], v[72:75], v[40:43], v[96:99]
    v_mfma_f32_16x16x32_bf16 v[96:99], v[76:79], v[44:47], v[96:99]
    s_add_u32 m0, s60, 28672
    s_waitcnt vmcnt(4)
    buffer_load_dwordx4 v12, s[44:47], s63 offen offset:0 nt lds
    v_mfma_f32_16x16x32_bf16 v[96:99], v[80:83], v[48:51], v[96:99]
    v_mfma_f32_16x16x32_bf16 v[96:99], v[84:87], v[52:55], v[96:99]
    v_mfma_f32_16x16x32_bf16 v[96:99], v[88:91], v[56:59], v[96:99]
    v_mfma_f32_16x16x32_bf16 v[96:99], v[92:95], v[60:63], v[96:99]
    s_add_u32 m0, s60, 28672
    s_waitcnt vmcnt(5)
    buffer_load_dwordx4 v14, s[44:47], s63 offen offset:2048 nt lds
    s_nop 4
    v_cvt_pk_bf16_f32 v100, v96, v97
    v_cvt_pk_bf16_f32 v101, v98, v99
    v_max3_f32 v28, v28, v96, v97
    v_max3_f32 v28, v28, v98, v99
    ds_write_b64 v23, v[100:101] offset:0
    s_add_u32 m0, s60, 24576
    s_waitcnt vmcnt(4)
    buffer_load_dwordx4 v9, s[44:47], s63 offen offset:1024 nt lds
    s_add_u32 m0, s60, 24576
    s_waitcnt vmcnt(4)
    buffer_load_dwordx4 v11, s[44:47], s63 offen offset:3072 nt lds
    s_add_u32 m0, s60, 28672
    s_waitcnt vmcnt(4)
    buffer_load_dwordx4 v13, s[44:47], s63 offen offset:1024 nt lds
    s_add_u32 m0, s60, 28672
    s_waitcnt vmcnt(5)
    buffer_load_dwordx4 v15, s[44:47], s63 offen offset:3072 nt lds
    s_add_u32 s62, s62, 4
    s_bfe_u32 s4, s62, 0x30002
    s_lshl_b32 s4, s4, 22
    s_add_u32 s63, s61, s4
    s_add_u32 s4, s62, s79
    s_and_b32 s4, s4, 3
    s_lshl_b32 s4, s4, 15
    s_add_u32 s63, s63, s4
    s_add_u32 s62, s62, 1
    s_add_u32 m0, s60, 0
    s_waitcnt vmcnt(4)
    buffer_load_dwordx4 v16, s[48:51], s63 offen offset:0 nt lds
    s_waitcnt vmcnt(16)
    ds_read_b128 v[64:67], v18 offset:8192
    ds_read_b128 v[68:71], v19 offset:8192
    ds_read_b128 v[72:75], v20 offset:8192
    ds_read_b128 v[76:79], v21 offset:8192
    ds_read_b128 v[80:83], v18 offset:8448
    ds_read_b128 v[84:87], v19 offset:8448
    ds_read_b128 v[88:91], v20 offset:8448
    ds_read_b128 v[92:95], v21 offset:8448
    s_add_u32 m0, s60, 0
    s_waitcnt vmcnt(4)
    buffer_load_dwordx4 v16, s[48:51], s63 offen offset:2048 nt lds
    s_waitcnt lgkmcnt(0)
    v_mfma_f32_16x16x32_bf16 v[96:99], v[64:67], v[32:35], 0
    v_mfma_f32_16x16x32_bf16 v[96:99], v[68:71], v[36:39], v[96:99]
    v_mfma_f32_16x16x32_bf16 v[96:99], v[72:75], v[40:43], v[96:99]
    v_mfma_f32_16x16x32_bf16 v[96:99], v[76:79], v[44:47], v[96:99]
    s_add_u32 m0, s60, 4096
    s_waitcnt vmcnt(4)
    buffer_load_dwordx4 v17, s[48:51], s63 offen offset:0 nt lds
    v_mfma_f32_16x16x32_bf16 v[96:99], v[80:83], v[48:51], v[96:99]
    v_mfma_f32_16x16x32_bf16 v[96:99], v[84:87], v[52:55], v[96:99]
    v_mfma_f32_16x16x32_bf16 v[96:99], v[88:91], v[56:59], v[96:99]
    v_mfma_f32_16x16x32_bf16 v[96:99], v[92:95], v[60:63], v[96:99]
    s_add_u32 m0, s60, 4096
    s_waitcnt vmcnt(5)
    buffer_load_dwordx4 v17, s[48:51], s63 offen offset:2048 nt lds
    s_nop 4
    v_cvt_pk_bf16_f32 v100, v96, v97
    v_cvt_pk_bf16_f32 v101, v98, v99
    v_max3_f32 v28, v28, v96, v97
    v_max3_f32 v28, v28, v98, v99
    ds_write_b64 v23, v[100:101] offset:64
    s_add_u32 m0, s60, 0
    s_waitcnt vmcnt(4)
    buffer_load_dwordx4 v16, s[48:51], s63 offen offset:1024 nt lds
    s_add_u32 m0, s60, 0
    s_waitcnt vmcnt(4)
    buffer_load_dwordx4 v16, s[48:51], s63 offen offset:3072 nt lds
    s_add_u32 m0, s60, 4096
    s_waitcnt vmcnt(4)
    buffer_load_dwordx4 v17, s[48:51], s63 offen offset:1024 nt lds
    s_add_u32 m0, s60, 4096
    s_waitcnt vmcnt(5)
    buffer_load_dwordx4 v17, s[48:51], s63 offen offset:3072 nt lds
    s_bfe_u32 s4, s62, 0x30002
    s_lshl_b32 s4, s4, 22
    s_add_u32 s63, s61, s4
    s_add_u32 s4, s62, s79
    s_and_b32 s4, s4, 3
    s_lshl_b32 s4, s4, 15
    s_add_u32 s63, s63, s4
    s_add_u32 s62, s62, 1
    s_add_u32 m0, s60, 8192
    s_waitcnt vmcnt(4)
    buffer_load_dwordx4 v16, s[48:51], s63 offen offset:0 nt lds
    s_waitcnt vmcnt(16)
    ds_read_b128 v[64:67], v18 offset:16384
    ds_read_b128 v[68:71], v19 offset:16384
    ds_read_b128 v[72:75], v20 offset:16384
    ds_read_b128 v[76:79], v21 offset:16384
    ds_read_b128 v[80:83], v18 offset:16640
    ds_read_b128 v[84:87], v19 offset:16640
    ds_read_b128 v[88:91], v20 offset:16640
    ds_read_b128 v[92:95], v21 offset:16640
    s_add_u32 m0, s60, 8192
    s_waitcnt vmcnt(4)
    buffer_load_dwordx4 v16, s[48:51], s63 offen offset:2048 nt lds
    s_waitcnt lgkmcnt(0)
    v_mfma_f32_16x16x32_bf16 v[96:99], v[64:67], v[32:35], 0
    v_mfma_f32_16x16x32_bf16 v[96:99], v[68:71], v[36:39], v[96:99]
    v_mfma_f32_16x16x32_bf16 v[96:99], v[72:75], v[40:43], v[96:99]
    v_mfma_f32_16x16x32_bf16 v[96:99], v[76:79], v[44:47], v[96:99]
    s_add_u32 m0, s60, 12288
    s_waitcnt vmcnt(4)
    buffer_load_dwordx4 v17, s[48:51], s63 offen offset:0 nt lds
    v_mfma_f32_16x16x32_bf16 v[96:99], v[80:83], v[48:51], v[96:99]
    v_mfma_f32_16x16x32_bf16 v[96:99], v[84:87], v[52:55], v[96:99]
    v_mfma_f32_16x16x32_bf16 v[96:99], v[88:91], v[56:59], v[96:99]
    v_mfma_f32_16x16x32_bf16 v[96:99], v[92:95], v[60:63], v[96:99]
    s_add_u32 m0, s60, 12288
    s_waitcnt vmcnt(5)
    buffer_load_dwordx4 v17, s[48:51], s63 offen offset:2048 nt lds
    s_nop 4
    v_cvt_pk_bf16_f32 v100, v96, v97
    v_cvt_pk_bf16_f32 v101, v98, v99
    v_max3_f32 v28, v28, v96, v97
    v_max3_f32 v28, v28, v98, v99
    ds_write_b64 v23, v[100:101] offset:128
    s_add_u32 m0, s60, 8192
    s_waitcnt vmcnt(4)
    buffer_load_dwordx4 v16, s[48:51], s63 offen offset:1024 nt lds
    s_add_u32 m0, s60, 8192
    s_waitcnt vmcnt(4)
    buffer_load_dwordx4 v16, s[48:51], s63 offen offset:3072 nt lds
    s_add_u32 m0, s60, 12288
    s_waitcnt vmcnt(4)
    buffer_load_dwordx4 v17, s[48:51], s63 offen offset:1024 nt lds
    s_add_u32 m0, s60, 12288
    s_waitcnt vmcnt(5)
    buffer_load_dwordx4 v17, s[48:51], s63 offen offset:3072 nt lds
    s_bfe_u32 s4, s62, 0x30002
    s_lshl_b32 s4, s4, 22
    s_add_u32 s63, s61, s4
    s_add_u32 s4, s62, s79
    s_and_b32 s4, s4, 3
    s_lshl_b32 s4, s4, 15
    s_add_u32 s63, s63, s4
    s_add_u32 s62, s62, 1
    s_add_u32 m0, s60, 16384
    s_waitcnt vmcnt(4)
    buffer_load_dwordx4 v16, s[48:51], s63 offen offset:0 nt lds
    s_waitcnt vmcnt(16)
    ds_read_b128 v[64:67], v18 offset:24576
    ds_read_b128 v[68:71], v19 offset:24576
    ds_read_b128 v[72:75], v20 offset:24576
    ds_read_b128 v[76:79], v21 offset:24576
    ds_read_b128 v[80:83], v18 offset:24832
    ds_read_b128 v[84:87], v19 offset:24832
    ds_read_b128 v[88:91], v20 offset:24832
    ds_read_b128 v[92:95], v21 offset:24832
    s_add_u32 m0, s60, 16384
    s_waitcnt vmcnt(4)
    buffer_load_dwordx4 v16, s[48:51], s63 offen offset:2048 nt lds
    s_waitcnt lgkmcnt(0)
    v_mfma_f32_16x16x32_bf16 v[96:99], v[64:67], v[32:35], 0
    v_mfma_f32_16x16x32_bf16 v[96:99], v[68:71], v[36:39], v[96:99]
    v_mfma_f32_16x16x32_bf16 v[96:99], v[72:75], v[40:43], v[96:99]
    v_mfma_f32_16x16x32_bf16 v[96:99], v[76:79], v[44:47], v[96:99]
    s_add_u32 m0, s60, 20480
    s_waitcnt vmcnt(4)
    buffer_load_dwordx4 v17, s[48:51], s63 offen offset:0 nt lds
    v_mfma_f32_16x16x32_bf16 v[96:99], v[80:83], v[48:51], v[96:99]
    v_mfma_f32_16x16x32_bf16 v[96:99], v[84:87], v[52:55], v[96:99]
    v_mfma_f32_16x16x32_bf16 v[96:99], v[88:91], v[56:59], v[96:99]
    v_mfma_f32_16x16x32_bf16 v[96:99], v[92:95], v[60:63], v[96:99]
    s_add_u32 m0, s60, 20480
    s_waitcnt vmcnt(5)
    buffer_load_dwordx4 v17, s[48:51], s63 offen offset:2048 nt lds
    s_nop 4
    v_cvt_pk_bf16_f32 v100, v96, v97
    v_cvt_pk_bf16_f32 v101, v98, v99
    v_max3_f32 v28, v28, v96, v97
    v_max3_f32 v28, v28, v98, v99
    ds_write_b64 v23, v[100:101] offset:192
    s_add_u32 m0, s60, 16384
    s_waitcnt vmcnt(4)
    buffer_load_dwordx4 v16, s[48:51], s63 offen offset:1024 nt lds
    s_add_u32 m0, s60, 16384
    s_waitcnt vmcnt(4)
    buffer_load_dwordx4 v16, s[48:51], s63 offen offset:3072 nt lds
    s_add_u32 m0, s60, 20480
    s_waitcnt vmcnt(4)
    buffer_load_dwordx4 v17, s[48:51], s63 offen offset:1024 nt lds
    s_add_u32 m0, s60, 20480
    s_waitcnt vmcnt(5)
    buffer_load_dwordx4 v17, s[48:51], s63 offen offset:3072 nt lds
    v_subrev_u32 v23, 1792, v23
    v_mov_b32 v48, 0
    v_mov_b32 v49, 0
    v_mov_b32 v50, 0
    v_mov_b32 v51, 0
    v_mov_b32 v52, 0
    v_mov_b32 v53, 0
    v_mov_b32 v54, 0
    v_mov_b32 v55, 0
    v_mov_b32 v31, v28
    s_nop 1
    v_permlane16_swap_b32 v28, v31
    v_max_f32 v28, v28, v31
    v_mov_b32 v31, v28
    s_nop 1
    v_permlane32_swap_b32 v28, v31
    v_max_f32 v28, v28, v31
    v_cvt_pk_bf16_f32 v28, v28, v28
    v_and_b32 v28, 0xffff0000, v28
    v_bfe_u32 v3, v2, 3, 1
    v_lshlrev_b32 v3, 4, v3
    v_add_u32 v3, 157696, v3
    s_lshl_b32 s64, s3, 2
    v_add_u32 v4, s64, v3
    ds_write_b32 v4, v28
    s_waitcnt lgkmcnt(0)
    s_barrier
    ds_read_b128 v[96:99], v3
    s_mov_b32 s65, 0x3db8aa3b
    s_waitcnt lgkmcnt(0)
    v_max_f32 v28, v96, v97
    v_max3_f32 v28, v28, v98, v99
    v_mul_f32 v30, s65, v28
    v_sub_f32 v30, 0, v30
    v_lshrrev_b32 v6, 5, v2
    v_lshlrev_b32 v6, 10, v6
    v_and_b32 v5, 15, v2
    v_lshl_add_u32 v6, v5, 5, v6
    v_bfe_u32 v5, v2, 4, 1
    v_lshl_add_u32 v6, v5, 4, v6
    v_add_u32 v6, s60, v6
    s_lshl_b32 s64, s3, 9
    v_lshlrev_b32 v4, 4, v2
    v_add_u32 v4, s64, v4
    v_add_u32 v5, 0x10000, v4
    s_lshr_b32 s64, s3, 1
    s_lshl_b32 s64, s64, 2
    s_add_u32 s64, s64, 157760
    v_mov_b32 v3, s64
    v_mov_b32 v102, 157808
    s_mov_b64 vcc, 0
    s_bfe_u32 s4, s62, 0x30002
    s_lshl_b32 s4, s4, 22
    s_add_u32 s63, s61, s4
    s_add_u32 s4, s62, s79
    s_and_b32 s4, s4, 3
    s_lshl_b32 s4, s4, 15
    s_add_u32 s63, s63, s4
    s_add_u32 s62, s62, 1
    s_add_u32 m0, s60, 24576
    s_waitcnt vmcnt(5)
    s_cbranch_vccnz L_bg3
    s_waitcnt vmcnt(4)
L_bg3:
    buffer_load_dwordx4 v16, s[48:51], s63 offen offset:0 nt lds
    ds_read_b64 v[100:101], v23 offset:256
    s_waitcnt lgkmcnt(0)
    v_lshlrev_b32 v56, 16, v100
    v_and_b32 v57, 0xffff0000, v100
    v_lshlrev_b32 v58, 16, v101
    v_and_b32 v59, 0xffff0000, v101
    v_fma_f32 v56, v56, s65, v30
    v_fma_f32 v57, v57, s65, v30
    v_fma_f32 v58, v58, s65, v30
    v_fma_f32 v59, v59, s65, v30
    v_exp_f32 v56, v56
    v_exp_f32 v57, v57
    v_exp_f32 v58, v58
    v_exp_f32 v59, v59
    s_nop 0
    v_cvt_pk_bf16_f32 v56, v56, v56
    v_cvt_pk_bf16_f32 v57, v57, v57
    v_cvt_pk_bf16_f32 v58, v58, v58
    v_cvt_pk_bf16_f32 v59, v59, v59
    s_add_u32 m0, s60, 24576
    s_waitcnt vmcnt(5)
    s_cbranch_vccnz L_bg4
    s_waitcnt vmcnt(4)
L_bg4:
    buffer_load_dwordx4 v16, s[48:51], s63 offen offset:2048 nt lds
    s_waitcnt vmcnt(16)
    ds_read_b128 v[64:67], v22 offset:0
    ds_read_b128 v[68:71], v22 offset:256
    ds_read_b128 v[72:75], v22 offset:2048
    ds_read_b128 v[76:79], v22 offset:2304
    ds_read_b128 v[80:83], v22 offset:4096
    ds_read_b128 v[84:87], v22 offset:4352
    ds_read_b128 v[88:91], v22 offset:6144
    ds_read_b128 v[92:95], v22 offset:6400
    v_and_b32 v32, v56, v24
    v_and_b32 v33, v56, v25
    v_and_b32 v34, v56, v26
    v_and_b32 v35, v56, v27
    v_and_b32 v36, v57, v24
    v_and_b32 v37, v57, v25
    v_and_b32 v38, v57, v26
    v_and_b32 v39, v57, v27
    v_and_b32 v40, v58, v24
    v_and_b32 v41, v58, v25
    v_and_b32 v42, v58, v26
    v_and_b32 v43, v58, v27
    v_and_b32 v44, v59, v24
    v_and_b32 v45, v59, v25
    v_and_b32 v46, v59, v26
    v_and_b32 v47, v59, v27
    s_waitcnt lgkmcnt(0)
    s_add_u32 m0, s60, 28672
    s_waitcnt vmcnt(5)
    s_cbranch_vccnz L_bg5
    s_waitcnt vmcnt(4)
L_bg5:
    buffer_load_dwordx4 v17, s[48:51], s63 offen offset:0 nt lds
    v_mfma_f32_16x16x32_bf16 v[48:51], v[32:35], v[64:67], v[48:51]
    v_mfma_f32_16x16x32_bf16 v[52:55], v[32:35], v[68:71], v[52:55]
    v_mfma_f32_16x16x32_bf16 v[48:51], v[36:39], v[72:75], v[48:51]
    v_mfma_f32_16x16x32_bf16 v[52:55], v[36:39], v[76:79], v[52:55]
    s_add_u32 m0, s60, 28672
    s_waitcnt vmcnt(5)
    buffer_load_dwordx4 v17, s[48:51], s63 offen offset:2048 nt lds
    v_mfma_f32_16x16x32_bf16 v[48:51], v[40:43], v[80:83], v[48:51]
    v_mfma_f32_16x16x32_bf16 v[52:55], v[40:43], v[84:87], v[52:55]
    v_mfma_f32_16x16x32_bf16 v[48:51], v[44:47], v[88:91], v[48:51]
    v_mfma_f32_16x16x32_bf16 v[52:55], v[44:47], v[92:95], v[52:55]
    s_add_u32 m0, s60, 24576
    s_waitcnt vmcnt(5)
    s_cbranch_vccnz L_bg6
    s_waitcnt vmcnt(4)
L_bg6:
    buffer_load_dwordx4 v16, s[48:51], s63 offen offset:1024 nt lds
    ds_read_b64 v[100:101], v23 offset:0
    s_waitcnt lgkmcnt(0)
    v_lshlrev_b32 v56, 16, v100
    v_and_b32 v57, 0xffff0000, v100
    v_lshlrev_b32 v58, 16, v101
    v_and_b32 v59, 0xffff0000, v101
    v_fma_f32 v56, v56, s65, v30
    v_fma_f32 v57, v57, s65, v30
    v_fma_f32 v58, v58, s65, v30
    v_fma_f32 v59, v59, s65, v30
    v_exp_f32 v56, v56
    v_exp_f32 v57, v57
    v_exp_f32 v58, v58
    v_exp_f32 v59, v59
    s_nop 0
    v_cvt_pk_bf16_f32 v56, v56, v56
    v_cvt_pk_bf16_f32 v57, v57, v57
    v_cvt_pk_bf16_f32 v58, v58, v58
    v_cvt_pk_bf16_f32 v59, v59, v59
    s_add_u32 m0, s60, 24576
    s_waitcnt vmcnt(5)
    s_cbranch_vccnz L_bg7
    s_waitcnt vmcnt(4)
L_bg7:
    buffer_load_dwordx4 v16, s[48:51], s63 offen offset:3072 nt lds
    v_and_b32 v32, v56, v24
    v_and_b32 v33, v56, v25
    v_and_b32 v34, v56, v26
    v_and_b32 v35, v56, v27
    v_and_b32 v36, v57, v24
    v_and_b32 v37, v57, v25
    v_and_b32 v38, v57, v26
    v_and_b32 v39, v57, v27
    v_and_b32 v40, v58, v24
    v_and_b32 v41, v58, v25
    v_and_b32 v42, v58, v26
    v_and_b32 v43, v58, v27
    v_and_b32 v44, v59, v24
    v_and_b32 v45, v59, v25
    v_and_b32 v46, v59, v26
    v_and_b32 v47, v59, v27
    s_add_u32 m0, s60, 28672
    s_waitcnt vmcnt(5)
    s_cbranch_vccnz L_bg8
    s_waitcnt vmcnt(4)
L_bg8:
    buffer_load_dwordx4 v17, s[48:51], s63 offen offset:1024 nt lds
    v_mfma_f32_16x16x32_bf16 v[48:51], v[32:35], v[104:107], v[48:51]
    v_mfma_f32_16x16x32_bf16 v[52:55], v[32:35], v[108:111], v[52:55]
    v_mfma_f32_16x16x32_bf16 v[48:51], v[36:39], v[112:115], v[48:51]
    v_mfma_f32_16x16x32_bf16 v[52:55], v[36:39], v[116:119], v[52:55]
    s_add_u32 m0, s60, 28672
    s_waitcnt vmcnt(5)
    buffer_load_dwordx4 v17, s[48:51], s63 offen offset:3072 nt lds
    v_mfma_f32_16x16x32_bf16 v[48:51], v[40:43], v[120:123], v[48:51]
    v_mfma_f32_16x16x32_bf16 v[52:55], v[40:43], v[124:127], v[52:55]
    v_mfma_f32_16x16x32_bf16 v[48:51], v[44:47], v[128:131], v[48:51]
    v_mfma_f32_16x16x32_bf16 v[52:55], v[44:47], v[132:135], v[52:55]
    s_bfe_u32 s4, s62, 0x30002
    s_lshl_b32 s4, s4, 22
    s_add_u32 s63, s61, s4
    s_add_u32 s4, s62, s79
    s_and_b32 s4, s4, 3
    s_lshl_b32 s4, s4, 15
    s_add_u32 s63, s63, s4
    s_add_u32 s62, s62, 1
    s_add_u32 m0, s60, 0
    s_waitcnt vmcnt(5)
    s_cbranch_vccnz L_bg9
    s_waitcnt vmcnt(4)
L_bg9:
    buffer_load_dwordx4 v16, s[48:51], s63 offen offset:0 nt lds
    ds_read_b64 v[100:101], v23 offset:320
    ds_read_b32 v96, v102
    s_waitcnt lgkmcnt(0)
    v_cmp_ne_u32 vcc, 0, v96
    v_lshlrev_b32 v56, 16, v100
    v_and_b32 v57, 0xffff0000, v100
    v_lshlrev_b32 v58, 16, v101
    v_and_b32 v59, 0xffff0000, v101
    v_fma_f32 v56, v56, s65, v30
    v_fma_f32 v57, v57, s65, v30
    v_fma_f32 v58, v58, s65, v30
    v_fma_f32 v59, v59, s65, v30
    v_exp_f32 v56, v56
    v_exp_f32 v57, v57
    v_exp_f32 v58, v58
    v_exp_f32 v59, v59
    s_nop 0
    v_cvt_pk_bf16_f32 v56, v56, v56
    v_cvt_pk_bf16_f32 v57, v57, v57
    v_cvt_pk_bf16_f32 v58, v58, v58
    v_cvt_pk_bf16_f32 v59, v59, v59
    s_add_u32 m0, s60, 0
    s_waitcnt vmcnt(5)
    s_cbranch_vccnz L_bg10
    s_waitcnt vmcnt(4)
L_bg10:
    buffer_load_dwordx4 v16, s[48:51], s63 offen offset:2048 nt lds
    s_waitcnt vmcnt(16)
    ds_read_b128 v[64:67], v22 offset:8192
    ds_read_b128 v[68:71], v22 offset:8448
    ds_read_b128 v[72:75], v22 offset:10240
    ds_read_b128 v[76:79], v22 offset:10496
    ds_read_b128 v[80:83], v22 offset:12288
    ds_read_b128 v[84:87], v22 offset:12544
    ds_read_b128 v[88:91], v22 offset:14336
    ds_read_b128 v[92:95], v22 offset:14592
    v_and_b32 v32, v56, v24
    v_and_b32 v33, v56, v25
    v_and_b32 v34, v56, v26
    v_and_b32 v35, v56, v27
    v_and_b32 v36, v57, v24
    v_and_b32 v37, v57, v25
    v_and_b32 v38, v57, v26
    v_and_b32 v39, v57, v27
    v_and_b32 v40, v58, v24
    v_and_b32 v41, v58, v25
    v_and_b32 v42, v58, v26
    v_and_b32 v43, v58, v27
    v_and_b32 v44, v59, v24
    v_and_b32 v45, v59, v25
    v_and_b32 v46, v59, v26
    v_and_b32 v47, v59, v27
    s_waitcnt lgkmcnt(0)
    s_add_u32 m0, s60, 4096
    s_waitcnt vmcnt(5)
    s_cbranch_vccnz L_bg11
    s_waitcnt vmcnt(4)
L_bg11:
    buffer_load_dwordx4 v17, s[48:51], s63 offen offset:0 nt lds
    v_mfma_f32_16x16x32_bf16 v[48:51], v[32:35], v[64:67], v[48:51]
    v_mfma_f32_16x16x32_bf16 v[52:55], v[32:35], v[68:71], v[52:55]
    v_mfma_f32_16x16x32_bf16 v[48:51], v[36:39], v[72:75], v[48:51]
    v_mfma_f32_16x16x32_bf16 v[52:55], v[36:39], v[76:79], v[52:55]
    s_add_u32 m0, s60, 4096
    s_waitcnt vmcnt(5)
    buffer_load_dwordx4 v17, s[48:51], s63 offen offset:2048 nt lds
    v_mfma_f32_16x16x32_bf16 v[48:51], v[40:43], v[80:83], v[48:51]
    v_mfma_f32_16x16x32_bf16 v[52:55], v[40:43], v[84:87], v[52:55]
    v_mfma_f32_16x16x32_bf16 v[48:51], v[44:47], v[88:91], v[48:51]
    v_mfma_f32_16x16x32_bf16 v[52:55], v[44:47], v[92:95], v[52:55]
    s_add_u32 m0, s60, 0
    s_waitcnt vmcnt(5)
    s_cbranch_vccnz L_bg12
    s_waitcnt vmcnt(4)
L_bg12:
    buffer_load_dwordx4 v16, s[48:51], s63 offen offset:1024 nt lds
    ds_read_b64 v[100:101], v23 offset:64
    s_waitcnt lgkmcnt(0)
    v_lshlrev_b32 v56, 16, v100
    v_and_b32 v57, 0xffff0000, v100
    v_lshlrev_b32 v58, 16, v101
    v_and_b32 v59, 0xffff0000, v101
    v_fma_f32 v56, v56, s65, v30
    v_fma_f32 v57, v57, s65, v30
    v_fma_f32 v58, v58, s65, v30
    v_fma_f32 v59, v59, s65, v30
    v_exp_f32 v56, v56
    v_exp_f32 v57, v57
    v_exp_f32 v58, v58
    v_exp_f32 v59, v59
    s_nop 0
    v_cvt_pk_bf16_f32 v56, v56, v56
    v_cvt_pk_bf16_f32 v57, v57, v57
    v_cvt_pk_bf16_f32 v58, v58, v58
    v_cvt_pk_bf16_f32 v59, v59, v59
    s_add_u32 m0, s60, 0
    s_waitcnt vmcnt(5)
    s_cbranch_vccnz L_bg13
    s_waitcnt vmcnt(4)
L_bg13:
    buffer_load_dwordx4 v16, s[48:51], s63 offen offset:3072 nt lds
    v_and_b32 v32, v56, v24
    v_and_b32 v33, v56, v25
    v_and_b32 v34, v56, v26
    v_and_b32 v35, v56, v27
    v_and_b32 v36, v57, v24
    v_and_b32 v37, v57, v25
    v_and_b32 v38, v57, v26
    v_and_b32 v39, v57, v27
    v_and_b32 v40, v58, v24
    v_and_b32 v41, v58, v25
    v_and_b32 v42, v58, v26
    v_and_b32 v43, v58, v27
    v_and_b32 v44, v59, v24
    v_and_b32 v45, v59, v25
    v_and_b32 v46, v59, v26
    v_and_b32 v47, v59, v27
    s_add_u32 m0, s60, 4096
    s_waitcnt vmcnt(5)
    s_cbranch_vccnz L_bg14
    s_waitcnt vmcnt(4)
L_bg14:
    buffer_load_dwordx4 v17, s[48:51], s63 offen offset:1024 nt lds
    v_mfma_f32_16x16x32_bf16 v[48:51], v[32:35], v[136:139], v[48:51]
    v_mfma_f32_16x16x32_bf16 v[52:55], v[32:35], v[140:143], v[52:55]
    v_mfma_f32_16x16x32_bf16 v[48:51], v[36:39], v[144:147], v[48:51]
    v_mfma_f32_16x16x32_bf16 v[52:55], v[36:39], v[148:151], v[52:55]
    s_add_u32 m0, s60, 4096
    s_waitcnt vmcnt(5)
    buffer_load_dwordx4 v17, s[48:51], s63 offen offset:3072 nt lds
    v_mfma_f32_16x16x32_bf16 v[48:51], v[40:43], v[152:155], v[48:51]
    v_mfma_f32_16x16x32_bf16 v[52:55], v[40:43], v[156:159], v[52:55]
    v_mfma_f32_16x16x32_bf16 v[48:51], v[44:47], v[160:163], v[48:51]
    v_mfma_f32_16x16x32_bf16 v[52:55], v[44:47], v[164:167], v[52:55]
    s_bfe_u32 s4, s62, 0x30002
    s_lshl_b32 s4, s4, 22
    s_add_u32 s63, s61, s4
    s_add_u32 s4, s62, s79
    s_and_b32 s4, s4, 3
    s_lshl_b32 s4, s4, 15
    s_add_u32 s63, s63, s4
    s_add_u32 s62, s62, 1
    s_add_u32 m0, s60, 8192
    s_waitcnt vmcnt(5)
    s_cbranch_vccnz L_bg15
    s_waitcnt vmcnt(4)
L_bg15:
    buffer_load_dwordx4 v16, s[48:51], s63 offen offset:0 nt lds
    ds_read_b64 v[100:101], v23 offset:384
    s_waitcnt lgkmcnt(0)
    v_lshlrev_b32 v56, 16, v100
    v_and_b32 v57, 0xffff0000, v100
    v_lshlrev_b32 v58, 16, v101
    v_and_b32 v59, 0xffff0000, v101
    v_fma_f32 v56, v56, s65, v30
    v_fma_f32 v57, v57, s65, v30
    v_fma_f32 v58, v58, s65, v30
    v_fma_f32 v59, v59, s65, v30
    v_exp_f32 v56, v56
    v_exp_f32 v57, v57
    v_exp_f32 v58, v58
    v_exp_f32 v59, v59
    s_nop 0
    v_cvt_pk_bf16_f32 v56, v56, v56
    v_cvt_pk_bf16_f32 v57, v57, v57
    v_cvt_pk_bf16_f32 v58, v58, v58
    v_cvt_pk_bf16_f32 v59, v59, v59
    s_add_u32 m0, s60, 8192
    s_waitcnt vmcnt(5)
    s_cbranch_vccnz L_bg16
    s_waitcnt vmcnt(4)
L_bg16:
    buffer_load_dwordx4 v16, s[48:51], s63 offen offset:2048 nt lds
    s_waitcnt vmcnt(16)
    ds_read_b128 v[64:67], v22 offset:16384
    ds_read_b128 v[68:71], v22 offset:16640
    ds_read_b128 v[72:75], v22 offset:18432
    ds_read_b128 v[76:79], v22 offset:18688
    ds_read_b128 v[80:83], v22 offset:20480
    ds_read_b128 v[84:87], v22 offset:20736
    ds_read_b128 v[88:91], v22 offset:22528
    ds_read_b128 v[92:95], v22 offset:22784
    v_and_b32 v32, v56, v24
    v_and_b32 v33, v56, v25
    v_and_b32 v34, v56, v26
    v_and_b32 v35, v56, v27
    v_and_b32 v36, v57, v24
    v_and_b32 v37, v57, v25
    v_and_b32 v38, v57, v26
    v_and_b32 v39, v57, v27
    v_and_b32 v40, v58, v24
    v_and_b32 v41, v58, v25
    v_and_b32 v42, v58, v26
    v_and_b32 v43, v58, v27
    v_and_b32 v44, v59, v24
    v_and_b32 v45, v59, v25
    v_and_b32 v46, v59, v26
    v_and_b32 v47, v59, v27
    s_waitcnt lgkmcnt(0)
    s_add_u32 m0, s60, 12288
    s_waitcnt vmcnt(5)
    s_cbranch_vccnz L_bg17
    s_waitcnt vmcnt(4)
L_bg17:
    buffer_load_dwordx4 v17, s[48:51], s63 offen offset:0 nt lds
    v_mfma_f32_16x16x32_bf16 v[48:51], v[32:35], v[64:67], v[48:51]
    v_mfma_f32_16x16x32_bf16 v[52:55], v[32:35], v[68:71], v[52:55]
    v_mfma_f32_16x16x32_bf16 v[48:51], v[36:39], v[72:75], v[48:51]
    v_mfma_f32_16x16x32_bf16 v[52:55], v[36:39], v[76:79], v[52:55]
    s_add_u32 m0, s60, 12288
    s_waitcnt vmcnt(5)
    buffer_load_dwordx4 v17, s[48:51], s63 offen offset:2048 nt lds
    v_mfma_f32_16x16x32_bf16 v[48:51], v[40:43], v[80:83], v[48:51]
    v_mfma_f32_16x16x32_bf16 v[52:55], v[40:43], v[84:87], v[52:55]
    v_mfma_f32_16x16x32_bf16 v[48:51], v[44:47], v[88:91], v[48:51]
    v_mfma_f32_16x16x32_bf16 v[52:55], v[44:47], v[92:95], v[52:55]
    s_add_u32 m0, s60, 8192
    s_waitcnt vmcnt(5)
    s_cbranch_vccnz L_bg18
    s_waitcnt vmcnt(4)
L_bg18:
    buffer_load_dwordx4 v16, s[48:51], s63 offen offset:1024 nt lds
    ds_read_b64 v[100:101], v23 offset:128
    s_waitcnt lgkmcnt(0)
    v_lshlrev_b32 v56, 16, v100
    v_and_b32 v57, 0xffff0000, v100
    v_lshlrev_b32 v58, 16, v101
    v_and_b32 v59, 0xffff0000, v101
    v_fma_f32 v56, v56, s65, v30
    v_fma_f32 v57, v57, s65, v30
    v_fma_f32 v58, v58, s65, v30
    v_fma_f32 v59, v59, s65, v30
    v_exp_f32 v56, v56
    v_exp_f32 v57, v57
    v_exp_f32 v58, v58
    v_exp_f32 v59, v59
    s_nop 0
    v_cvt_pk_bf16_f32 v56, v56, v56
    v_cvt_pk_bf16_f32 v57, v57, v57
    v_cvt_pk_bf16_f32 v58, v58, v58
    v_cvt_pk_bf16_f32 v59, v59, v59
    s_add_u32 m0, s60, 8192
    s_waitcnt vmcnt(5)
    s_cbranch_vccnz L_bg19
    s_waitcnt vmcnt(4)
L_bg19:
    buffer_load_dwordx4 v16, s[48:51], s63 offen offset:3072 nt lds
    v_and_b32 v32, v56, v24
    v_and_b32 v33, v56, v25
    v_and_b32 v34, v56, v26
    v_and_b32 v35, v56, v27
    v_and_b32 v36, v57, v24
    v_and_b32 v37, v57, v25
    v_and_b32 v38, v57, v26
    v_and_b32 v39, v57, v27
    v_and_b32 v40, v58, v24
    v_and_b32 v41, v58, v25
    v_and_b32 v42, v58, v26
    v_and_b32 v43, v58, v27
    v_and_b32 v44, v59, v24
    v_and_b32 v45, v59, v25
    v_and_b32 v46, v59, v26
    v_and_b32 v47, v59, v27
    s_add_u32 m0, s60, 12288
    s_waitcnt vmcnt(5)
    s_cbranch_vccnz L_bg20
    s_waitcnt vmcnt(4)
L_bg20:
    buffer_load_dwordx4 v17, s[48:51], s63 offen offset:1024 nt lds
    v_mfma_f32_16x16x32_bf16 v[48:51], v[32:35], v[168:171], v[48:51]
    v_mfma_f32_16x16x32_bf16 v[52:55], v[32:35], v[172:175], v[52:55]
    v_mfma_f32_16x16x32_bf16 v[48:51], v[36:39], v[176:179], v[48:51]
    v_mfma_f32_16x16x32_bf16 v[52:55], v[36:39], v[180:183], v[52:55]
    s_add_u32 m0, s60, 12288
    s_waitcnt vmcnt(5)
    buffer_load_dwordx4 v17, s[48:51], s63 offen offset:3072 nt lds
    v_mfma_f32_16x16x32_bf16 v[48:51], v[40:43], v[184:187], v[48:51]
    v_mfma_f32_16x16x32_bf16 v[52:55], v[40:43], v[188:191], v[52:55]
    v_mfma_f32_16x16x32_bf16 v[48:51], v[44:47], v[192:195], v[48:51]
    v_mfma_f32_16x16x32_bf16 v[52:55], v[44:47], v[196:199], v[52:55]
    s_bfe_u32 s4, s62, 0x30002
    s_lshl_b32 s4, s4, 22
    s_add_u32 s63, s61, s4
    s_add_u32 s4, s62, s79
    s_and_b32 s4, s4, 3
    s_lshl_b32 s4, s4, 15
    s_add_u32 s63, s63, s4
    s_add_u32 s62, s62, 1
    s_add_u32 m0, s60, 16384
    s_waitcnt vmcnt(5)
    s_cbranch_vccnz L_bg21
    s_waitcnt vmcnt(4)
L_bg21:
    buffer_load_dwordx4 v16, s[48:51], s63 offen offset:0 nt lds
    ds_read_b64 v[100:101], v23 offset:448
    ds_read_b32 v96, v102
    s_waitcnt lgkmcnt(0)
    v_cmp_ne_u32 vcc, 0, v96
    v_lshlrev_b32 v56, 16, v100
    v_and_b32 v57, 0xffff0000, v100
    v_lshlrev_b32 v58, 16, v101
    v_and_b32 v59, 0xffff0000, v101
    v_fma_f32 v56, v56, s65, v30
    v_fma_f32 v57, v57, s65, v30
    v_fma_f32 v58, v58, s65, v30
    v_fma_f32 v59, v59, s65, v30
    v_exp_f32 v56, v56
    v_exp_f32 v57, v57
    v_exp_f32 v58, v58
    v_exp_f32 v59, v59
    s_nop 0
    v_cvt_pk_bf16_f32 v56, v56, v56
    v_cvt_pk_bf16_f32 v57, v57, v57
    v_cvt_pk_bf16_f32 v58, v58, v58
    v_cvt_pk_bf16_f32 v59, v59, v59
    s_add_u32 m0, s60, 16384
    s_waitcnt vmcnt(5)
    s_cbranch_vccnz L_bg22
    s_waitcnt vmcnt(4)
L_bg22:
    buffer_load_dwordx4 v16, s[48:51], s63 offen offset:2048 nt lds
    s_waitcnt vmcnt(16)
    ds_read_b128 v[64:67], v22 offset:24576
    ds_read_b128 v[68:71], v22 offset:24832
    ds_read_b128 v[72:75], v22 offset:26624
    ds_read_b128 v[76:79], v22 offset:26880
    ds_read_b128 v[80:83], v22 offset:28672
    ds_read_b128 v[84:87], v22 offset:28928
    ds_read_b128 v[88:91], v22 offset:30720
    ds_read_b128 v[92:95], v22 offset:30976
    v_and_b32 v32, v56, v24
    v_and_b32 v33, v56, v25
    v_and_b32 v34, v56, v26
    v_and_b32 v35, v56, v27
    v_and_b32 v36, v57, v24
    v_and_b32 v37, v57, v25
    v_and_b32 v38, v57, v26
    v_and_b32 v39, v57, v27
    v_and_b32 v40, v58, v24
    v_and_b32 v41, v58, v25
    v_and_b32 v42, v58, v26
    v_and_b32 v43, v58, v27
    v_and_b32 v44, v59, v24
    v_and_b32 v45, v59, v25
    v_and_b32 v46, v59, v26
    v_and_b32 v47, v59, v27
    s_waitcnt lgkmcnt(0)
    s_add_u32 m0, s60, 20480
    s_waitcnt vmcnt(5)
    s_cbranch_vccnz L_bg23
    s_waitcnt vmcnt(4)
L_bg23:
    buffer_load_dwordx4 v17, s[48:51], s63 offen offset:0 nt lds
    v_mfma_f32_16x16x32_bf16 v[48:51], v[32:35], v[64:67], v[48:51]
    v_mfma_f32_16x16x32_bf16 v[52:55], v[32:35], v[68:71], v[52:55]
    v_mfma_f32_16x16x32_bf16 v[48:51], v[36:39], v[72:75], v[48:51]
    v_mfma_f32_16x16x32_bf16 v[52:55], v[36:39], v[76:79], v[52:55]
    s_add_u32 m0, s60, 20480
    s_waitcnt vmcnt(5)
    buffer_load_dwordx4 v17, s[48:51], s63 offen offset:2048 nt lds
    v_mfma_f32_16x16x32_bf16 v[48:51], v[40:43], v[80:83], v[48:51]
    v_mfma_f32_16x16x32_bf16 v[52:55], v[40:43], v[84:87], v[52:55]
    v_mfma_f32_16x16x32_bf16 v[48:51], v[44:47], v[88:91], v[48:51]
    v_mfma_f32_16x16x32_bf16 v[52:55], v[44:47], v[92:95], v[52:55]
    s_add_u32 m0, s60, 16384
    s_waitcnt vmcnt(5)
    s_cbranch_vccnz L_bg24
    s_waitcnt vmcnt(4)
L_bg24:
    buffer_load_dwordx4 v16, s[48:51], s63 offen offset:1024 nt lds
    ds_read_b64 v[100:101], v23 offset:192
    s_waitcnt lgkmcnt(0)
    v_lshlrev_b32 v56, 16, v100
    v_and_b32 v57, 0xffff0000, v100
    v_lshlrev_b32 v58, 16, v101
    v_and_b32 v59, 0xffff0000, v101
    v_fma_f32 v56, v56, s65, v30
    v_fma_f32 v57, v57, s65, v30
    v_fma_f32 v58, v58, s65, v30
    v_fma_f32 v59, v59, s65, v30
    v_exp_f32 v56, v56
    v_exp_f32 v57, v57
    v_exp_f32 v58, v58
    v_exp_f32 v59, v59
    s_nop 0
    v_cvt_pk_bf16_f32 v56, v56, v56
    v_cvt_pk_bf16_f32 v57, v57, v57
    v_cvt_pk_bf16_f32 v58, v58, v58
    v_cvt_pk_bf16_f32 v59, v59, v59
    s_add_u32 m0, s60, 16384
    s_waitcnt vmcnt(5)
    s_cbranch_vccnz L_bg25
    s_waitcnt vmcnt(4)
L_bg25:
    buffer_load_dwordx4 v16, s[48:51], s63 offen offset:3072 nt lds
    v_and_b32 v32, v56, v24
    v_and_b32 v33, v56, v25
    v_and_b32 v34, v56, v26
    v_and_b32 v35, v56, v27
    v_and_b32 v36, v57, v24
    v_and_b32 v37, v57, v25
    v_and_b32 v38, v57, v26
    v_and_b32 v39, v57, v27
    v_and_b32 v40, v58, v24
    v_and_b32 v41, v58, v25
    v_and_b32 v42, v58, v26
    v_and_b32 v43, v58, v27
    v_and_b32 v44, v59, v24
    v_and_b32 v45, v59, v25
    v_and_b32 v46, v59, v26
    v_and_b32 v47, v59, v27
    s_add_u32 m0, s60, 20480
    s_waitcnt vmcnt(5)
    s_cbranch_vccnz L_bg26
    s_waitcnt vmcnt(4)
L_bg26:
    buffer_load_dwordx4 v17, s[48:51], s63 offen offset:1024 nt lds
    v_mfma_f32_16x16x32_bf16 v[48:51], v[32:35], v[200:203], v[48:51]
    v_mfma_f32_16x16x32_bf16 v[52:55], v[32:35], v[204:207], v[52:55]
    v_mfma_f32_16x16x32_bf16 v[48:51], v[36:39], v[208:211], v[48:51]
    v_mfma_f32_16x16x32_bf16 v[52:55], v[36:39], v[212:215], v[52:55]
    s_add_u32 m0, s60, 20480
    s_waitcnt vmcnt(5)
    buffer_load_dwordx4 v17, s[48:51], s63 offen offset:3072 nt lds
    v_mfma_f32_16x16x32_bf16 v[48:51], v[40:43], v[216:219], v[48:51]
    v_mfma_f32_16x16x32_bf16 v[52:55], v[40:43], v[220:223], v[52:55]
    v_mfma_f32_16x16x32_bf16 v[48:51], v[44:47], v[224:227], v[48:51]
    v_mfma_f32_16x16x32_bf16 v[52:55], v[44:47], v[228:231], v[52:55]
    v_add_u32 v23, 512, v23
    s_mov_b32 s64, 4
L_vloop2:
    s_bfe_u32 s4, s62, 0x30002
    s_lshl_b32 s4, s4, 22
    s_add_u32 s63, s61, s4
    s_add_u32 s4, s62, s79
    s_and_b32 s4, s4, 3
    s_lshl_b32 s4, s4, 15
    s_add_u32 s63, s63, s4
    s_add_u32 s62, s62, 1
    s_add_u32 m0, s60, 24576
    s_waitcnt vmcnt(5)
    s_cbranch_vccnz L_bg27
    s_waitcnt vmcnt(4)
L_bg27:
    buffer_load_dwordx4 v16, s[48:51], s63 offen offset:0 nt lds
    ds_read_b64 v[100:101], v23 offset:0
    s_waitcnt lgkmcnt(0)
    v_lshlrev_b32 v56, 16, v100
    v_and_b32 v57, 0xffff0000, v100
    v_lshlrev_b32 v58, 16, v101
    v_and_b32 v59, 0xffff0000, v101
    v_fma_f32 v56, v56, s65, v30
    v_fma_f32 v57, v57, s65, v30
    v_fma_f32 v58, v58, s65, v30
    v_fma_f32 v59, v59, s65, v30
    v_exp_f32 v56, v56
    v_exp_f32 v57, v57
    v_exp_f32 v58, v58
    v_exp_f32 v59, v59
    s_nop 0
    v_cvt_pk_bf16_f32 v56, v56, v56
    v_cvt_pk_bf16_f32 v57, v57, v57
    v_cvt_pk_bf16_f32 v58, v58, v58
    v_cvt_pk_bf16_f32 v59, v59, v59
    s_add_u32 m0, s60, 24576
    s_waitcnt vmcnt(5)
    s_cbranch_vccnz L_bg28
    s_waitcnt vmcnt(4)
L_bg28:
    buffer_load_dwordx4 v16, s[48:51], s63 offen offset:2048 nt lds
    s_waitcnt vmcnt(16)
    ds_read_b128 v[64:67], v22 offset:0
    ds_read_b128 v[68:71], v22 offset:256
    ds_read_b128 v[72:75], v22 offset:2048
    ds_read_b128 v[76:79], v22 offset:2304
    ds_read_b128 v[80:83], v22 offset:4096
    ds_read_b128 v[84:87], v22 offset:4352
    ds_read_b128 v[88:91], v22 offset:6144
    ds_read_b128 v[92:95], v22 offset:6400
    v_and_b32 v32, v56, v24
    v_and_b32 v33, v56, v25
    v_and_b32 v34, v56, v26
    v_and_b32 v35, v56, v27
    v_and_b32 v36, v57, v24
    v_and_b32 v37, v57, v25
    v_and_b32 v38, v57, v26
    v_and_b32 v39, v57, v27
    v_and_b32 v40, v58, v24
    v_and_b32 v41, v58, v25
    v_and_b32 v42, v58, v26
    v_and_b32 v43, v58, v27
    v_and_b32 v44, v59, v24
    v_and_b32 v45, v59, v25
    v_and_b32 v46, v59, v26
    v_and_b32 v47, v59, v27
    s_waitcnt lgkmcnt(0)
    s_add_u32 m0, s60, 28672
    s_waitcnt vmcnt(5)
    s_cbranch_vccnz L_bg29
    s_waitcnt vmcnt(4)
L_bg29:
    buffer_load_dwordx4 v17, s[48:51], s63 offen offset:0 nt lds
    v_mfma_f32_16x16x32_bf16 v[48:51], v[32:35], v[64:67], v[48:51]
    v_mfma_f32_16x16x32_bf16 v[52:55], v[32:35], v[68:71], v[52:55]
    v_mfma_f32_16x16x32_bf16 v[48:51], v[36:39], v[72:75], v[48:51]
    v_mfma_f32_16x16x32_bf16 v[52:55], v[36:39], v[76:79], v[52:55]
    s_add_u32 m0, s60, 28672
    s_waitcnt vmcnt(5)
    buffer_load_dwordx4 v17, s[48:51], s63 offen offset:2048 nt lds
    v_mfma_f32_16x16x32_bf16 v[48:51], v[40:43], v[80:83], v[48:51]
    v_mfma_f32_16x16x32_bf16 v[52:55], v[40:43], v[84:87], v[52:55]
    v_mfma_f32_16x16x32_bf16 v[48:51], v[44:47], v[88:91], v[48:51]
    v_mfma_f32_16x16x32_bf16 v[52:55], v[44:47], v[92:95], v[52:55]
    s_add_u32 m0, s60, 24576
    s_waitcnt vmcnt(5)
    s_cbranch_vccnz L_bg30
    s_waitcnt vmcnt(4)
L_bg30:
    buffer_load_dwordx4 v16, s[48:51], s63 offen offset:1024 nt lds
    s_add_u32 m0, s60, 24576
    s_waitcnt vmcnt(5)
    s_cbranch_vccnz L_bg31
    s_waitcnt vmcnt(4)
L_bg31:
    buffer_load_dwordx4 v16, s[48:51], s63 offen offset:3072 nt lds
    s_add_u32 m0, s60, 28672
    s_waitcnt vmcnt(5)
    s_cbranch_vccnz L_bg32
    s_waitcnt vmcnt(4)
L_bg32:
    buffer_load_dwordx4 v17, s[48:51], s63 offen offset:1024 nt lds
    s_add_u32 m0, s60, 28672
    s_waitcnt vmcnt(5)
    buffer_load_dwordx4 v17, s[48:51], s63 offen offset:3072 nt lds
    s_bfe_u32 s4, s62, 0x30002
    s_lshl_b32 s4, s4, 22
    s_add_u32 s63, s61, s4
    s_add_u32 s4, s62, s79
    s_and_b32 s4, s4, 3
    s_lshl_b32 s4, s4, 15
    s_add_u32 s63, s63, s4
    s_add_u32 s62, s62, 1
    s_add_u32 m0, s60, 0
    s_waitcnt vmcnt(5)
    s_cbranch_vccnz L_bg33
    s_waitcnt vmcnt(4)
L_bg33:
    buffer_load_dwordx4 v16, s[48:51], s63 offen offset:0 nt lds
    ds_read_b64 v[100:101], v23 offset:64
    ds_read_b32 v96, v102
    s_waitcnt lgkmcnt(0)
    v_cmp_ne_u32 vcc, 0, v96
    v_lshlrev_b32 v56, 16, v100
    v_and_b32 v57, 0xffff0000, v100
    v_lshlrev_b32 v58, 16, v101
    v_and_b32 v59, 0xffff0000, v101
    v_fma_f32 v56, v56, s65, v30
    v_fma_f32 v57, v57, s65, v30
    v_fma_f32 v58, v58, s65, v30
    v_fma_f32 v59, v59, s65, v30
    v_exp_f32 v56, v56
    v_exp_f32 v57, v57
    v_exp_f32 v58, v58
    v_exp_f32 v59, v59
    s_nop 0
    v_cvt_pk_bf16_f32 v56, v56, v56
    v_cvt_pk_bf16_f32 v57, v57, v57
    v_cvt_pk_bf16_f32 v58, v58, v58
    v_cvt_pk_bf16_f32 v59, v59, v59
    s_add_u32 m0, s60, 0
    s_waitcnt vmcnt(5)
    s_cbranch_vccnz L_bg34
    s_waitcnt vmcnt(4)
L_bg34:
    buffer_load_dwordx4 v16, s[48:51], s63 offen offset:2048 nt lds
    s_waitcnt vmcnt(16)
    ds_read_b128 v[64:67], v22 offset:8192
    ds_read_b128 v[68:71], v22 offset:8448
    ds_read_b128 v[72:75], v22 offset:10240
    ds_read_b128 v[76:79], v22 offset:10496
    ds_read_b128 v[80:83], v22 offset:12288
    ds_read_b128 v[84:87], v22 offset:12544
    ds_read_b128 v[88:91], v22 offset:14336
    ds_read_b128 v[92:95], v22 offset:14592
    v_and_b32 v32, v56, v24
    v_and_b32 v33, v56, v25
    v_and_b32 v34, v56, v26
    v_and_b32 v35, v56, v27
    v_and_b32 v36, v57, v24
    v_and_b32 v37, v57, v25
    v_and_b32 v38, v57, v26
    v_and_b32 v39, v57, v27
    v_and_b32 v40, v58, v24
    v_and_b32 v41, v58, v25
    v_and_b32 v42, v58, v26
    v_and_b32 v43, v58, v27
    v_and_b32 v44, v59, v24
    v_and_b32 v45, v59, v25
    v_and_b32 v46, v59, v26
    v_and_b32 v47, v59, v27
    s_waitcnt lgkmcnt(0)
    s_add_u32 m0, s60, 4096
    s_waitcnt vmcnt(5)
    s_cbranch_vccnz L_bg35
    s_waitcnt vmcnt(4)
L_bg35:
    buffer_load_dwordx4 v17, s[48:51], s63 offen offset:0 nt lds
    v_mfma_f32_16x16x32_bf16 v[48:51], v[32:35], v[64:67], v[48:51]
    v_mfma_f32_16x16x32_bf16 v[52:55], v[32:35], v[68:71], v[52:55]
    v_mfma_f32_16x16x32_bf16 v[48:51], v[36:39], v[72:75], v[48:51]
    v_mfma_f32_16x16x32_bf16 v[52:55], v[36:39], v[76:79], v[52:55]
    s_add_u32 m0, s60, 4096
    s_waitcnt vmcnt(5)
    buffer_load_dwordx4 v17, s[48:51], s63 offen offset:2048 nt lds
    v_mfma_f32_16x16x32_bf16 v[48:51], v[40:43], v[80:83], v[48:51]
    v_mfma_f32_16x16x32_bf16 v[52:55], v[40:43], v[84:87], v[52:55]
    v_mfma_f32_16x16x32_bf16 v[48:51], v[44:47], v[88:91], v[48:51]
    v_mfma_f32_16x16x32_bf16 v[52:55], v[44:47], v[92:95], v[52:55]
    s_add_u32 m0, s60, 0
    s_waitcnt vmcnt(5)
    s_cbranch_vccnz L_bg36
    s_waitcnt vmcnt(4)
L_bg36:
    buffer_load_dwordx4 v16, s[48:51], s63 offen offset:1024 nt lds
    s_add_u32 m0, s60, 0
    s_waitcnt vmcnt(5)
    s_cbranch_vccnz L_bg37
    s_waitcnt vmcnt(4)
L_bg37:
    buffer_load_dwordx4 v16, s[48:51], s63 offen offset:3072 nt lds
    s_add_u32 m0, s60, 4096
    s_waitcnt vmcnt(5)
    s_cbranch_vccnz L_bg38
    s_waitcnt vmcnt(4)
L_bg38:
    buffer_load_dwordx4 v17, s[48:51], s63 offen offset:1024 nt lds
    s_add_u32 m0, s60, 4096
    s_waitcnt vmcnt(5)
    buffer_load_dwordx4 v17, s[48:51], s63 offen offset:3072 nt lds
    s_bfe_u32 s4, s62, 0x30002
    s_lshl_b32 s4, s4, 22
    s_add_u32 s63, s61, s4
    s_add_u32 s4, s62, s79
    s_and_b32 s4, s4, 3
    s_lshl_b32 s4, s4, 15
    s_add_u32 s63, s63, s4
    s_add_u32 s62, s62, 1
    s_add_u32 m0, s60, 8192
    s_waitcnt vmcnt(5)
    s_cbranch_vccnz L_bg39
    s_waitcnt vmcnt(4)
L_bg39:
    buffer_load_dwordx4 v16, s[48:51], s63 offen offset:0 nt lds
    ds_read_b64 v[100:101], v23 offset:128
    s_waitcnt lgkmcnt(0)
    v_lshlrev_b32 v56, 16, v100
    v_and_b32 v57, 0xffff0000, v100
    v_lshlrev_b32 v58, 16, v101
    v_and_b32 v59, 0xffff0000, v101
    v_fma_f32 v56, v56, s65, v30
    v_fma_f32 v57, v57, s65, v30
    v_fma_f32 v58, v58, s65, v30
    v_fma_f32 v59, v59, s65, v30
    v_exp_f32 v56, v56
    v_exp_f32 v57, v57
    v_exp_f32 v58, v58
    v_exp_f32 v59, v59
    s_nop 0
    v_cvt_pk_bf16_f32 v56, v56, v56
    v_cvt_pk_bf16_f32 v57, v57, v57
    v_cvt_pk_bf16_f32 v58, v58, v58
    v_cvt_pk_bf16_f32 v59, v59, v59
    s_add_u32 m0, s60, 8192
    s_waitcnt vmcnt(5)
    s_cbranch_vccnz L_bg40
    s_waitcnt vmcnt(4)
L_bg40:
    buffer_load_dwordx4 v16, s[48:51], s63 offen offset:2048 nt lds
    s_waitcnt vmcnt(16)
    ds_read_b128 v[64:67], v22 offset:16384
    ds_read_b128 v[68:71], v22 offset:16640
    ds_read_b128 v[72:75], v22 offset:18432
    ds_read_b128 v[76:79], v22 offset:18688
    ds_read_b128 v[80:83], v22 offset:20480
    ds_read_b128 v[84:87], v22 offset:20736
    ds_read_b128 v[88:91], v22 offset:22528
    ds_read_b128 v[92:95], v22 offset:22784
    v_and_b32 v32, v56, v24
    v_and_b32 v33, v56, v25
    v_and_b32 v34, v56, v26
    v_and_b32 v35, v56, v27
    v_and_b32 v36, v57, v24
    v_and_b32 v37, v57, v25
    v_and_b32 v38, v57, v26
    v_and_b32 v39, v57, v27
    v_and_b32 v40, v58, v24
    v_and_b32 v41, v58, v25
    v_and_b32 v42, v58, v26
    v_and_b32 v43, v58, v27
    v_and_b32 v44, v59, v24
    v_and_b32 v45, v59, v25
    v_and_b32 v46, v59, v26
    v_and_b32 v47, v59, v27
    s_waitcnt lgkmcnt(0)
    s_add_u32 m0, s60, 12288
    s_waitcnt vmcnt(5)
    s_cbranch_vccnz L_bg41
    s_waitcnt vmcnt(4)
L_bg41:
    buffer_load_dwordx4 v17, s[48:51], s63 offen offset:0 nt lds
    v_mfma_f32_16x16x32_bf16 v[48:51], v[32:35], v[64:67], v[48:51]
    v_mfma_f32_16x16x32_bf16 v[52:55], v[32:35], v[68:71], v[52:55]
    v_mfma_f32_16x16x32_bf16 v[48:51], v[36:39], v[72:75], v[48:51]
    v_mfma_f32_16x16x32_bf16 v[52:55], v[36:39], v[76:79], v[52:55]
    s_add_u32 m0, s60, 12288
    s_waitcnt vmcnt(5)
    buffer_load_dwordx4 v17, s[48:51], s63 offen offset:2048 nt lds
    v_mfma_f32_16x16x32_bf16 v[48:51], v[40:43], v[80:83], v[48:51]
    v_mfma_f32_16x16x32_bf16 v[52:55], v[40:43], v[84:87], v[52:55]
    v_mfma_f32_16x16x32_bf16 v[48:51], v[44:47], v[88:91], v[48:51]
    v_mfma_f32_16x16x32_bf16 v[52:55], v[44:47], v[92:95], v[52:55]
    s_add_u32 m0, s60, 8192
    s_waitcnt vmcnt(5)
    s_cbranch_vccnz L_bg42
    s_waitcnt vmcnt(4)
L_bg42:
    buffer_load_dwordx4 v16, s[48:51], s63 offen offset:1024 nt lds
    s_add_u32 m0, s60, 8192
    s_waitcnt vmcnt(5)
    s_cbranch_vccnz L_bg43
    s_waitcnt vmcnt(4)
L_bg43:
    buffer_load_dwordx4 v16, s[48:51], s63 offen offset:3072 nt lds
    s_add_u32 m0, s60, 12288
    s_waitcnt vmcnt(5)
    s_cbranch_vccnz L_bg44
    s_waitcnt vmcnt(4)
L_bg44:
    buffer_load_dwordx4 v17, s[48:51], s63 offen offset:1024 nt lds
    s_add_u32 m0, s60, 12288
    s_waitcnt vmcnt(5)
    buffer_load_dwordx4 v17, s[48:51], s63 offen offset:3072 nt lds
    s_bfe_u32 s4, s62, 0x30002
    s_lshl_b32 s4, s4, 22
    s_add_u32 s63, s61, s4
    s_add_u32 s4, s62, s79
    s_and_b32 s4, s4, 3
    s_lshl_b32 s4, s4, 15
    s_add_u32 s63, s63, s4
    s_add_u32 s62, s62, 1
    s_add_u32 m0, s60, 16384
    s_waitcnt vmcnt(5)
    s_cbranch_vccnz L_bg45
    s_waitcnt vmcnt(4)
L_bg45:
    buffer_load_dwordx4 v16, s[48:51], s63 offen offset:0 nt lds
    ds_read_b64 v[100:101], v23 offset:192
    ds_read_b32 v96, v102
    s_waitcnt lgkmcnt(0)
    v_cmp_ne_u32 vcc, 0, v96
    v_lshlrev_b32 v56, 16, v100
    v_and_b32 v57, 0xffff0000, v100
    v_lshlrev_b32 v58, 16, v101
    v_and_b32 v59, 0xffff0000, v101
    v_fma_f32 v56, v56, s65, v30
    v_fma_f32 v57, v57, s65, v30
    v_fma_f32 v58, v58, s65, v30
    v_fma_f32 v59, v59, s65, v30
    v_exp_f32 v56, v56
    v_exp_f32 v57, v57
    v_exp_f32 v58, v58
    v_exp_f32 v59, v59
    s_nop 0
    v_cvt_pk_bf16_f32 v56, v56, v56
    v_cvt_pk_bf16_f32 v57, v57, v57
    v_cvt_pk_bf16_f32 v58, v58, v58
    v_cvt_pk_bf16_f32 v59, v59, v59
    s_add_u32 m0, s60, 16384
    s_waitcnt vmcnt(5)
    s_cbranch_vccnz L_bg46
    s_waitcnt vmcnt(4)
L_bg46:
    buffer_load_dwordx4 v16, s[48:51], s63 offen offset:2048 nt lds
    s_waitcnt vmcnt(16)
    ds_read_b128 v[64:67], v22 offset:24576
    ds_read_b128 v[68:71], v22 offset:24832
    ds_read_b128 v[72:75], v22 offset:26624
    ds_read_b128 v[76:79], v22 offset:26880
    ds_read_b128 v[80:83], v22 offset:28672
    ds_read_b128 v[84:87], v22 offset:28928
    ds_read_b128 v[88:91], v22 offset:30720
    ds_read_b128 v[92:95], v22 offset:30976
    v_and_b32 v32, v56, v24
    v_and_b32 v33, v56, v25
    v_and_b32 v34, v56, v26
    v_and_b32 v35, v56, v27
    v_and_b32 v36, v57, v24
    v_and_b32 v37, v57, v25
    v_and_b32 v38, v57, v26
    v_and_b32 v39, v57, v27
    v_and_b32 v40, v58, v24
    v_and_b32 v41, v58, v25
    v_and_b32 v42, v58, v26
    v_and_b32 v43, v58, v27
    v_and_b32 v44, v59, v24
    v_and_b32 v45, v59, v25
    v_and_b32 v46, v59, v26
    v_and_b32 v47, v59, v27
    s_waitcnt lgkmcnt(0)
    s_add_u32 m0, s60, 20480
    s_waitcnt vmcnt(5)
    s_cbranch_vccnz L_bg47
    s_waitcnt vmcnt(4)
L_bg47:
    buffer_load_dwordx4 v17, s[48:51], s63 offen offset:0 nt lds
    v_mfma_f32_16x16x32_bf16 v[48:51], v[32:35], v[64:67], v[48:51]
    v_mfma_f32_16x16x32_bf16 v[52:55], v[32:35], v[68:71], v[52:55]
    v_mfma_f32_16x16x32_bf16 v[48:51], v[36:39], v[72:75], v[48:51]
    v_mfma_f32_16x16x32_bf16 v[52:55], v[36:39], v[76:79], v[52:55]
    s_add_u32 m0, s60, 20480
    s_waitcnt vmcnt(5)
    buffer_load_dwordx4 v17, s[48:51], s63 offen offset:2048 nt lds
    v_mfma_f32_16x16x32_bf16 v[48:51], v[40:43], v[80:83], v[48:51]
    v_mfma_f32_16x16x32_bf16 v[52:55], v[40:43], v[84:87], v[52:55]
    v_mfma_f32_16x16x32_bf16 v[48:51], v[44:47], v[88:91], v[48:51]
    v_mfma_f32_16x16x32_bf16 v[52:55], v[44:47], v[92:95], v[52:55]
    s_add_u32 m0, s60, 16384
    s_waitcnt vmcnt(5)
    s_cbranch_vccnz L_bg48
    s_waitcnt vmcnt(4)
L_bg48:
    buffer_load_dwordx4 v16, s[48:51], s63 offen offset:1024 nt lds
    s_add_u32 m0, s60, 16384
    s_waitcnt vmcnt(5)
    s_cbranch_vccnz L_bg49
    s_waitcnt vmcnt(4)
L_bg49:
    buffer_load_dwordx4 v16, s[48:51], s63 offen offset:3072 nt lds
    s_add_u32 m0, s60, 20480
    s_waitcnt vmcnt(5)
    s_cbranch_vccnz L_bg50
    s_waitcnt vmcnt(4)
L_bg50:
    buffer_load_dwordx4 v17, s[48:51], s63 offen offset:1024 nt lds
    s_add_u32 m0, s60, 20480
    s_waitcnt vmcnt(5)
    buffer_load_dwordx4 v17, s[48:51], s63 offen offset:3072 nt lds
    v_add_u32 v23, 256, v23
    s_sub_u32 s64, s64, 1
    s_cmp_lg_u32 s64, 0
    s_cbranch_scc1 L_vloop2
L_poolcode:
    v_mov_b32 v31, 157792
    s_mov_b32 s64, 0
L_rw51:
    ds_read_b32 v96, v31
    s_add_u32 s64, s64, 1
    s_lshr_b32 s4, s2, 5
    s_lshl_b32 s5, s4, 2
    s_add_u32 s5, s5, s3
    s_mul_i32 s5, s5, 4352
    s_add_u32 s5, s5, 2621440
    s_add_u32 s76, s40, s5
    s_addc_u32 s77, s41, 0
    s_mov_b32 s71, 2
    s_and_b32 s9, s2, 224
    s_lshl_b32 s9, s9, 10
    s_lshl_b32 s5, s3, 6
    s_add_u32 s9, s9, s5
    s_add_u32 s9, s9, 2097152
    v_bfe_u32 v103, v2, 3, 1
    v_lshlrev_b32 v103, 5, v103
    v_lshrrev_b32 v97, 4, v2
    v_lshl_add_u32 v103, v97, 3, v103
    s_waitcnt lgkmcnt(0)
    v_readfirstlane_b32 s4, v96
    s_cmp_lg_u32 s4, 0
    s_cbranch_scc1 L_rwd52
    s_sleep 4
    s_cmp_lt_u32 s64, 1048576
    s_cbranch_scc1 L_rw51
L_rwd52:
    s_bfe_u32 s4, s62, 0x30002
    s_lshl_b32 s4, s4, 22
    s_add_u32 s63, s61, s4
    s_add_u32 s4, s62, s79
    s_and_b32 s4, s4, 3
    s_lshl_b32 s4, s4, 15
    s_add_u32 s63, s63, s4
    s_add_u32 s62, s62, 1
    s_add_u32 m0, s60, 24576
    s_waitcnt vmcnt(5)
    s_cbranch_vccnz L_bg53
    s_waitcnt vmcnt(4)
L_bg53:
    buffer_load_dwordx4 v16, s[48:51], s63 offen offset:0 nt lds
    ds_read_b64 v[100:101], v23 offset:0
    s_waitcnt lgkmcnt(0)
    v_lshlrev_b32 v56, 16, v100
    v_and_b32 v57, 0xffff0000, v100
    v_lshlrev_b32 v58, 16, v101
    v_and_b32 v59, 0xffff0000, v101
    v_fma_f32 v56, v56, s65, v30
    v_fma_f32 v57, v57, s65, v30
    v_fma_f32 v58, v58, s65, v30
    v_fma_f32 v59, v59, s65, v30
    v_exp_f32 v56, v56
    v_exp_f32 v57, v57
    v_exp_f32 v58, v58
    v_exp_f32 v59, v59
    s_nop 0
    v_cvt_pk_bf16_f32 v56, v56, v56
    v_cvt_pk_bf16_f32 v57, v57, v57
    v_cvt_pk_bf16_f32 v58, v58, v58
    v_cvt_pk_bf16_f32 v59, v59, v59
    s_add_u32 m0, s60, 24576
    s_waitcnt vmcnt(5)
    s_cbranch_vccnz L_bg54
    s_waitcnt vmcnt(4)
L_bg54:
    buffer_load_dwordx4 v16, s[48:51], s63 offen offset:2048 nt lds
    s_waitcnt vmcnt(16)
    ds_read_b128 v[64:67], v22 offset:0
    ds_read_b128 v[68:71], v22 offset:256
    ds_read_b128 v[72:75], v22 offset:2048
    ds_read_b128 v[76:79], v22 offset:2304
    ds_read_b128 v[80:83], v22 offset:4096
    ds_read_b128 v[84:87], v22 offset:4352
    ds_read_b128 v[88:91], v22 offset:6144
    ds_read_b128 v[92:95], v22 offset:6400
    v_and_b32 v32, v56, v24
    v_and_b32 v33, v56, v25
    v_and_b32 v34, v56, v26
    v_and_b32 v35, v56, v27
    v_and_b32 v36, v57, v24
    v_and_b32 v37, v57, v25
    v_and_b32 v38, v57, v26
    v_and_b32 v39, v57, v27
    v_and_b32 v40, v58, v24
    v_and_b32 v41, v58, v25
    v_and_b32 v42, v58, v26
    v_and_b32 v43, v58, v27
    v_and_b32 v44, v59, v24
    v_and_b32 v45, v59, v25
    v_and_b32 v46, v59, v26
    v_and_b32 v47, v59, v27
    s_waitcnt lgkmcnt(0)
    s_add_u32 m0, s60, 28672
    s_waitcnt vmcnt(5)
    s_cbranch_vccnz L_bg55
    s_waitcnt vmcnt(4)
L_bg55:
    buffer_load_dwordx4 v17, s[48:51], s63 offen offset:0 nt lds
    v_mfma_f32_16x16x32_bf16 v[48:51], v[32:35], v[64:67], v[48:51]
    v_mfma_f32_16x16x32_bf16 v[52:55], v[32:35], v[68:71], v[52:55]
    v_mfma_f32_16x16x32_bf16 v[48:51], v[36:39], v[72:75], v[48:51]
    v_mfma_f32_16x16x32_bf16 v[52:55], v[36:39], v[76:79], v[52:55]
    s_add_u32 m0, s60, 28672
    s_waitcnt vmcnt(5)
    buffer_load_dwordx4 v17, s[48:51], s63 offen offset:2048 nt lds
    v_mfma_f32_16x16x32_bf16 v[48:51], v[40:43], v[80:83], v[48:51]
    v_mfma_f32_16x16x32_bf16 v[52:55], v[40:43], v[84:87], v[52:55]
    v_mfma_f32_16x16x32_bf16 v[48:51], v[44:47], v[88:91], v[48:51]
    v_mfma_f32_16x16x32_bf16 v[52:55], v[44:47], v[92:95], v[52:55]
    s_mov_b32 s70, 1
    s_atomic_add s70, s[76:77], 0 glc
    s_add_u32 m0, s60, 24576
    s_waitcnt vmcnt(5)
    s_cbranch_vccnz L_bg56
    s_waitcnt vmcnt(4)
L_bg56:
    buffer_load_dwordx4 v16, s[48:51], s63 offen offset:1024 nt lds
    s_add_u32 m0, s60, 24576
    s_waitcnt vmcnt(5)
    s_cbranch_vccnz L_bg57
    s_waitcnt vmcnt(4)
L_bg57:
    buffer_load_dwordx4 v16, s[48:51], s63 offen offset:3072 nt lds
    s_add_u32 m0, s60, 28672
    s_waitcnt vmcnt(5)
    s_cbranch_vccnz L_bg58
    s_waitcnt vmcnt(4)
L_bg58:
    buffer_load_dwordx4 v17, s[48:51], s63 offen offset:1024 nt lds
    s_add_u32 m0, s60, 28672
    s_waitcnt vmcnt(5)
    buffer_load_dwordx4 v17, s[48:51], s63 offen offset:3072 nt lds
    s_waitcnt lgkmcnt(0)
    s_mov_b32 s72, -1
    s_cmp_ge_u32 s70, 128
    s_cbranch_scc1 L_ps59
    s_and_b32 s5, s70, 31
    s_lshr_b32 s6, s70, 5
    s_lshl_b32 s7, s5, 10
    s_lshl_b32 s8, s6, 8
    s_add_u32 s72, s7, s8
    s_and_b32 s7, s2, 0
    s_or_b32 s5, s5, s7
    s_mul_i32 s7, s5, 0
    s_lshl_b32 s5, s5, 17
    s_add_u32 s5, s5, s78
    s_add_u32 s6, s6, s68
    s_bfe_u32 s4, s6, 0x30002
    s_lshl_b32 s4, s4, 22
    s_add_u32 s63, s5, s4
    s_add_u32 s4, s6, s7
    s_and_b32 s4, s4, 3
    s_lshl_b32 s4, s4, 15
    s_add_u32 s63, s63, s4
    s_add_u32 s4, s72, s9
    buffer_load_dwordx2 v[104:105], v103, s[56:59], s4 offen sc1
    s_add_u32 m0, s60, 0
    s_waitcnt vmcnt(15)
    buffer_load_dwordx4 v16, s[48:51], s63 offen offset:0 nt lds
L_ps59:
    ds_read_b64 v[100:101], v23 offset:64
    s_waitcnt lgkmcnt(0)
    v_lshlrev_b32 v56, 16, v100
    v_and_b32 v57, 0xffff0000, v100
    v_lshlrev_b32 v58, 16, v101
    v_and_b32 v59, 0xffff0000, v101
    v_fma_f32 v56, v56, s65, v30
    v_fma_f32 v57, v57, s65, v30
    v_fma_f32 v58, v58, s65, v30
    v_fma_f32 v59, v59, s65, v30
    v_exp_f32 v56, v56
    v_exp_f32 v57, v57
    v_exp_f32 v58, v58
    v_exp_f32 v59, v59
    s_nop 0
    v_cvt_pk_bf16_f32 v56, v56, v56
    v_cvt_pk_bf16_f32 v57, v57, v57
    v_cvt_pk_bf16_f32 v58, v58, v58
    v_cvt_pk_bf16_f32 v59, v59, v59
    s_cmp_eq_u32 s72, -1
    s_cbranch_scc1 L_ps61
    s_add_u32 m0, s60, 0
    s_waitcnt vmcnt(15)
    buffer_load_dwordx4 v16, s[48:51], s63 offen offset:2048 nt lds
L_ps61:
    s_waitcnt vmcnt(16)
    s_cmp_ge_i32 s71, 2
    s_cbranch_scc1 L_wy62
    s_waitcnt vmcnt(8)
    s_cmp_ge_i32 s71, 1
    s_cbranch_scc1 L_wy62
    s_waitcnt vmcnt(0)
L_wy62:
    ds_read_b128 v[64:67], v22 offset:8192
    ds_read_b128 v[68:71], v22 offset:8448
    ds_read_b128 v[72:75], v22 offset:10240
    ds_read_b128 v[76:79], v22 offset:10496
    ds_read_b128 v[80:83], v22 offset:12288
    ds_read_b128 v[84:87], v22 offset:12544
    ds_read_b128 v[88:91], v22 offset:14336
    ds_read_b128 v[92:95], v22 offset:14592
    v_and_b32 v32, v56, v24
    v_and_b32 v33, v56, v25
    v_and_b32 v34, v56, v26
    v_and_b32 v35, v56, v27
    v_and_b32 v36, v57, v24
    v_and_b32 v37, v57, v25
    v_and_b32 v38, v57, v26
    v_and_b32 v39, v57, v27
    v_and_b32 v40, v58, v24
    v_and_b32 v41, v58, v25
    v_and_b32 v42, v58, v26
    v_and_b32 v43, v58, v27
    v_and_b32 v44, v59, v24
    v_and_b32 v45, v59, v25
    v_and_b32 v46, v59, v26
    v_and_b32 v47, v59, v27
    s_waitcnt lgkmcnt(0)
    s_cmp_eq_u32 s72, -1
    s_cbranch_scc1 L_ps63
    s_add_u32 m0, s60, 4096
    s_waitcnt vmcnt(15)
    buffer_load_dwordx4 v17, s[48:51], s63 offen offset:0 nt lds
L_ps63:
    v_mfma_f32_16x16x32_bf16 v[48:51], v[32:35], v[64:67], v[48:51]
    v_mfma_f32_16x16x32_bf16 v[52:55], v[32:35], v[68:71], v[52:55]
    v_mfma_f32_16x16x32_bf16 v[48:51], v[36:39], v[72:75], v[48:51]
    v_mfma_f32_16x16x32_bf16 v[52:55], v[36:39], v[76:79], v[52:55]
    s_cmp_eq_u32 s72, -1
    s_cbranch_scc1 L_ps64
    s_add_u32 m0, s60, 4096
    s_waitcnt vmcnt(15)
    buffer_load_dwordx4 v17, s[48:51], s63 offen offset:2048 nt lds
L_ps64:
    v_mfma_f32_16x16x32_bf16 v[48:51], v[40:43], v[80:83], v[48:51]
    v_mfma_f32_16x16x32_bf16 v[52:55], v[40:43], v[84:87], v[52:55]
    v_mfma_f32_16x16x32_bf16 v[48:51], v[44:47], v[88:91], v[48:51]
    v_mfma_f32_16x16x32_bf16 v[52:55], v[44:47], v[92:95], v[52:55]
    s_cmp_eq_u32 s72, -1
    s_cbranch_scc1 L_ps65
    s_mov_b32 s70, 1
    s_atomic_add s70, s[76:77], 0 glc
    s_add_u32 m0, s60, 0
    s_waitcnt vmcnt(15)
    buffer_load_dwordx4 v16, s[48:51], s63 offen offset:1024 nt lds
L_ps65:
    s_cmp_eq_u32 s72, -1
    s_cbranch_scc1 L_ps66
    s_add_u32 m0, s60, 0
    s_waitcnt vmcnt(15)
    buffer_load_dwordx4 v16, s[48:51], s63 offen offset:3072 nt lds
L_ps66:
    s_cmp_eq_u32 s72, -1
    s_cbranch_scc1 L_ps67
    s_add_u32 m0, s60, 4096
    s_waitcnt vmcnt(15)
    buffer_load_dwordx4 v17, s[48:51], s63 offen offset:1024 nt lds
L_ps67:
    s_cmp_eq_u32 s72, -1
    s_cbranch_scc1 L_ps68
    s_add_u32 m0, s60, 4096
    s_waitcnt vmcnt(15)
    buffer_load_dwordx4 v17, s[48:51], s63 offen offset:3072 nt lds
L_ps68:
    s_cmp_eq_u32 s72, -1
    s_subb_u32 s71, s71, 0
    s_waitcnt lgkmcnt(0)
    s_mov_b32 s73, -1
    s_cmp_ge_u32 s70, 128
    s_cbranch_scc1 L_ps69
    s_and_b32 s5, s70, 31
    s_lshr_b32 s6, s70, 5
    s_lshl_b32 s7, s5, 10
    s_lshl_b32 s8, s6, 8
    s_add_u32 s73, s7, s8
    s_and_b32 s7, s2, 0
    s_or_b32 s5, s5, s7
    s_mul_i32 s7, s5, 0
    s_lshl_b32 s5, s5, 17
    s_add_u32 s5, s5, s78
    s_add_u32 s6, s6, s68
    s_bfe_u32 s4, s6, 0x30002
    s_lshl_b32 s4, s4, 22
    s_add_u32 s63, s5, s4
    s_add_u32 s4, s6, s7
    s_and_b32 s4, s4, 3
    s_lshl_b32 s4, s4, 15
    s_add_u32 s63, s63, s4
    s_add_u32 s4, s73, s9
    buffer_load_dwordx2 v[106:107], v103, s[56:59], s4 offen sc1
    s_add_u32 m0, s60, 8192
    s_waitcnt vmcnt(15)
    buffer_load_dwordx4 v16, s[48:51], s63 offen offset:0 nt lds
L_ps69:
    ds_read_b64 v[100:101], v23 offset:128
    s_waitcnt lgkmcnt(0)
    v_lshlrev_b32 v56, 16, v100
    v_and_b32 v57, 0xffff0000, v100
    v_lshlrev_b32 v58, 16, v101
    v_and_b32 v59, 0xffff0000, v101
    v_fma_f32 v56, v56, s65, v30
    v_fma_f32 v57, v57, s65, v30
    v_fma_f32 v58, v58, s65, v30
    v_fma_f32 v59, v59, s65, v30
    v_exp_f32 v56, v56
    v_exp_f32 v57, v57
    v_exp_f32 v58, v58
    v_exp_f32 v59, v59
    s_nop 0
    v_cvt_pk_bf16_f32 v56, v56, v56
    v_cvt_pk_bf16_f32 v57, v57, v57
    v_cvt_pk_bf16_f32 v58, v58, v58
    v_cvt_pk_bf16_f32 v59, v59, v59
    s_cmp_eq_u32 s73, -1
    s_cbranch_scc1 L_ps71
    s_add_u32 m0, s60, 8192
    s_waitcnt vmcnt(15)
    buffer_load_dwordx4 v16, s[48:51], s63 offen offset:2048 nt lds
L_ps71:
    s_waitcnt vmcnt(16)
    s_cmp_ge_i32 s71, 2
    s_cbranch_scc1 L_wy72
    s_waitcnt vmcnt(8)
    s_cmp_ge_i32 s71, 1
    s_cbranch_scc1 L_wy72
    s_waitcnt vmcnt(0)
L_wy72:
    ds_read_b128 v[64:67], v22 offset:16384
    ds_read_b128 v[68:71], v22 offset:16640
    ds_read_b128 v[72:75], v22 offset:18432
    ds_read_b128 v[76:79], v22 offset:18688
    ds_read_b128 v[80:83], v22 offset:20480
    ds_read_b128 v[84:87], v22 offset:20736
    ds_read_b128 v[88:91], v22 offset:22528
    ds_read_b128 v[92:95], v22 offset:22784
    v_and_b32 v32, v56, v24
    v_and_b32 v33, v56, v25
    v_and_b32 v34, v56, v26
    v_and_b32 v35, v56, v27
    v_and_b32 v36, v57, v24
    v_and_b32 v37, v57, v25
    v_and_b32 v38, v57, v26
    v_and_b32 v39, v57, v27
    v_and_b32 v40, v58, v24
    v_and_b32 v41, v58, v25
    v_and_b32 v42, v58, v26
    v_and_b32 v43, v58, v27
    v_and_b32 v44, v59, v24
    v_and_b32 v45, v59, v25
    v_and_b32 v46, v59, v26
    v_and_b32 v47, v59, v27
    s_waitcnt lgkmcnt(0)
    s_cmp_eq_u32 s73, -1
    s_cbranch_scc1 L_ps73
    s_add_u32 m0, s60, 12288
    s_waitcnt vmcnt(15)
    buffer_load_dwordx4 v17, s[48:51], s63 offen offset:0 nt lds
L_ps73:
    v_mfma_f32_16x16x32_bf16 v[48:51], v[32:35], v[64:67], v[48:51]
    v_mfma_f32_16x16x32_bf16 v[52:55], v[32:35], v[68:71], v[52:55]
    v_mfma_f32_16x16x32_bf16 v[48:51], v[36:39], v[72:75], v[48:51]
    v_mfma_f32_16x16x32_bf16 v[52:55], v[36:39], v[76:79], v[52:55]
    s_cmp_eq_u32 s73, -1
    s_cbranch_scc1 L_ps74
    s_add_u32 m0, s60, 12288
    s_waitcnt vmcnt(15)
    buffer_load_dwordx4 v17, s[48:51], s63 offen offset:2048 nt lds
L_ps74:
    v_mfma_f32_16x16x32_bf16 v[48:51], v[40:43], v[80:83], v[48:51]
    v_mfma_f32_16x16x32_bf16 v[52:55], v[40:43], v[84:87], v[52:55]
    v_mfma_f32_16x16x32_bf16 v[48:51], v[44:47], v[88:91], v[48:51]
    v_mfma_f32_16x16x32_bf16 v[52:55], v[44:47], v[92:95], v[52:55]
    s_cmp_eq_u32 s73, -1
    s_cbranch_scc1 L_ps75
    s_mov_b32 s70, 1
    s_atomic_add s70, s[76:77], 0 glc
    s_add_u32 m0, s60, 8192
    s_waitcnt vmcnt(15)
    buffer_load_dwordx4 v16, s[48:51], s63 offen offset:1024 nt lds
L_ps75:
    s_cmp_eq_u32 s73, -1
    s_cbranch_scc1 L_ps76
    s_add_u32 m0, s60, 8192
    s_waitcnt vmcnt(15)
    buffer_load_dwordx4 v16, s[48:51], s63 offen offset:3072 nt lds
L_ps76:
    s_cmp_eq_u32 s73, -1
    s_cbranch_scc1 L_ps77
    s_add_u32 m0, s60, 12288
    s_waitcnt vmcnt(15)
    buffer_load_dwordx4 v17, s[48:51], s63 offen offset:1024 nt lds
L_ps77:
    s_cmp_eq_u32 s73, -1
    s_cbranch_scc1 L_ps78
    s_add_u32 m0, s60, 12288
    s_waitcnt vmcnt(15)
    buffer_load_dwordx4 v17, s[48:51], s63 offen offset:3072 nt lds
L_ps78:
    s_cmp_eq_u32 s73, -1
    s_subb_u32 s71, s71, 0
    s_waitcnt lgkmcnt(0)
    s_mov_b32 s74, -1
    s_cmp_ge_u32 s70, 128
    s_cbranch_scc1 L_ps79
    s_and_b32 s5, s70, 31
    s_lshr_b32 s6, s70, 5
    s_lshl_b32 s7, s5, 10
    s_lshl_b32 s8, s6, 8
    s_add_u32 s74, s7, s8
    s_and_b32 s7, s2, 0
    s_or_b32 s5, s5, s7
    s_mul_i32 s7, s5, 0
    s_lshl_b32 s5, s5, 17
    s_add_u32 s5, s5, s78
    s_add_u32 s6, s6, s68
    s_bfe_u32 s4, s6, 0x30002
    s_lshl_b32 s4, s4, 22
    s_add_u32 s63, s5, s4
    s_add_u32 s4, s6, s7
    s_and_b32 s4, s4, 3
    s_lshl_b32 s4, s4, 15
    s_add_u32 s63, s63, s4
    s_add_u32 s4, s74, s9
    buffer_load_dwordx2 v[108:109], v103, s[56:59], s4 offen sc1
    s_add_u32 m0, s60, 16384
    s_waitcnt vmcnt(15)
    buffer_load_dwordx4 v16, s[48:51], s63 offen offset:0 nt lds
L_ps79:
    ds_read_b64 v[100:101], v23 offset:192
    s_waitcnt lgkmcnt(0)
    v_lshlrev_b32 v56, 16, v100
    v_and_b32 v57, 0xffff0000, v100
    v_lshlrev_b32 v58, 16, v101
    v_and_b32 v59, 0xffff0000, v101
    v_fma_f32 v56, v56, s65, v30
    v_fma_f32 v57, v57, s65, v30
    v_fma_f32 v58, v58, s65, v30
    v_fma_f32 v59, v59, s65, v30
    v_exp_f32 v56, v56
    v_exp_f32 v57, v57
    v_exp_f32 v58, v58
    v_exp_f32 v59, v59
    s_nop 0
    v_cvt_pk_bf16_f32 v56, v56, v56
    v_cvt_pk_bf16_f32 v57, v57, v57
    v_cvt_pk_bf16_f32 v58, v58, v58
    v_cvt_pk_bf16_f32 v59, v59, v59
    s_cmp_eq_u32 s74, -1
    s_cbranch_scc1 L_ps81
    s_add_u32 m0, s60, 16384
    s_waitcnt vmcnt(15)
    buffer_load_dwordx4 v16, s[48:51], s63 offen offset:2048 nt lds
L_ps81:
    s_waitcnt vmcnt(16)
    s_cmp_ge_i32 s71, 2
    s_cbranch_scc1 L_wy82
    s_waitcnt vmcnt(8)
    s_cmp_ge_i32 s71, 1
    s_cbranch_scc1 L_wy82
    s_waitcnt vmcnt(0)
L_wy82:
    ds_read_b128 v[64:67], v22 offset:24576
    ds_read_b128 v[68:71], v22 offset:24832
    ds_read_b128 v[72:75], v22 offset:26624
    ds_read_b128 v[76:79], v22 offset:26880
    ds_read_b128 v[80:83], v22 offset:28672
    ds_read_b128 v[84:87], v22 offset:28928
    ds_read_b128 v[88:91], v22 offset:30720
    ds_read_b128 v[92:95], v22 offset:30976
    v_and_b32 v32, v56, v24
    v_and_b32 v33, v56, v25
    v_and_b32 v34, v56, v26
    v_and_b32 v35, v56, v27
    v_and_b32 v36, v57, v24
    v_and_b32 v37, v57, v25
    v_and_b32 v38, v57, v26
    v_and_b32 v39, v57, v27
    v_and_b32 v40, v58, v24
    v_and_b32 v41, v58, v25
    v_and_b32 v42, v58, v26
    v_and_b32 v43, v58, v27
    v_and_b32 v44, v59, v24
    v_and_b32 v45, v59, v25
    v_and_b32 v46, v59, v26
    v_and_b32 v47, v59, v27
    s_waitcnt lgkmcnt(0)
    s_cmp_eq_u32 s74, -1
    s_cbranch_scc1 L_ps83
    s_add_u32 m0, s60, 20480
    s_waitcnt vmcnt(15)
    buffer_load_dwordx4 v17, s[48:51], s63 offen offset:0 nt lds
L_ps83:
    v_mfma_f32_16x16x32_bf16 v[48:51], v[32:35], v[64:67], v[48:51]
    v_mfma_f32_16x16x32_bf16 v[52:55], v[32:35], v[68:71], v[52:55]
    v_mfma_f32_16x16x32_bf16 v[48:51], v[36:39], v[72:75], v[48:51]
    v_mfma_f32_16x16x32_bf16 v[52:55], v[36:39], v[76:79], v[52:55]
    s_cmp_eq_u32 s74, -1
    s_cbranch_scc1 L_ps84
    s_add_u32 m0, s60, 20480
    s_waitcnt vmcnt(15)
    buffer_load_dwordx4 v17, s[48:51], s63 offen offset:2048 nt lds
L_ps84:
    v_mfma_f32_16x16x32_bf16 v[48:51], v[40:43], v[80:83], v[48:51]
    v_mfma_f32_16x16x32_bf16 v[52:55], v[40:43], v[84:87], v[52:55]
    v_mfma_f32_16x16x32_bf16 v[48:51], v[44:47], v[88:91], v[48:51]
    v_mfma_f32_16x16x32_bf16 v[52:55], v[44:47], v[92:95], v[52:55]
    s_cmp_eq_u32 s74, -1
    s_cbranch_scc1 L_ps85
    s_mov_b32 s70, 1
    s_atomic_add s70, s[76:77], 0 glc
    s_add_u32 m0, s60, 16384
    s_waitcnt vmcnt(15)
    buffer_load_dwordx4 v16, s[48:51], s63 offen offset:1024 nt lds
L_ps85:
    s_cmp_eq_u32 s74, -1
    s_cbranch_scc1 L_ps86
    s_add_u32 m0, s60, 16384
    s_waitcnt vmcnt(15)
    buffer_load_dwordx4 v16, s[48:51], s63 offen offset:3072 nt lds
L_ps86:
    s_cmp_eq_u32 s74, -1
    s_cbranch_scc1 L_ps87
    s_add_u32 m0, s60, 20480
    s_waitcnt vmcnt(15)
    buffer_load_dwordx4 v17, s[48:51], s63 offen offset:1024 nt lds
L_ps87:
    s_cmp_eq_u32 s74, -1
    s_cbranch_scc1 L_ps88
    s_add_u32 m0, s60, 20480
    s_waitcnt vmcnt(15)
    buffer_load_dwordx4 v17, s[48:51], s63 offen offset:3072 nt lds
L_ps88:
    s_cmp_eq_u32 s74, -1
    s_subb_u32 s71, s71, 0
    v_lshrrev_b32 v31, 5, v2
    v_lshlrev_b32 v31, 2, v31
    v_add_u32 v31, 157768, v31
    ds_read_b32 v96, v31
    v_bfe_u32 v31, v2, 3, 1
    v_lshlrev_b32 v23, 5, v31
    v_lshlrev_b32 v31, 2, v31
    v_add_u32 v31, 157776, v31
    ds_read_b32 v30, v31
    v_lshrrev_b32 v31, 4, v2
    v_lshl_add_u32 v23, v31, 3, v23
    s_lshl_b32 s4, s3, 6
    s_add_u32 s4, s4, 139264
    v_add_u32 v23, s4, v23
    s_waitcnt lgkmcnt(0)
    v_mul_f32 v48, v48, v96
    v_mul_f32 v49, v49, v96
    v_mul_f32 v50, v50, v96
    v_mul_f32 v51, v51, v96
    v_mul_f32 v52, v52, v96
    v_mul_f32 v53, v53, v96
    v_mul_f32 v54, v54, v96
    v_mul_f32 v55, v55, v96
L_ploop89:
    s_waitcnt lgkmcnt(0)
    s_cmp_ge_u32 s70, 128
    s_cbranch_scc1 L_drain91
    s_and_b32 s5, s70, 31
    s_lshr_b32 s6, s70, 5
    s_lshl_b32 s7, s5, 10
    s_lshl_b32 s8, s6, 8
    s_add_u32 s75, s7, s8
    s_and_b32 s7, s2, 0
    s_or_b32 s5, s5, s7
    s_mul_i32 s7, s5, 0
    s_lshl_b32 s5, s5, 17
    s_add_u32 s5, s5, s78
    s_add_u32 s6, s6, s68
    s_bfe_u32 s4, s6, 0x30002
    s_lshl_b32 s4, s4, 22
    s_add_u32 s63, s5, s4
    s_add_u32 s4, s6, s7
    s_and_b32 s4, s4, 3
    s_lshl_b32 s4, s4, 15
    s_add_u32 s63, s63, s4
    s_add_u32 s4, s75, s9
    buffer_load_dwordx2 v[110:111], v103, s[56:59], s4 offen sc1
    s_add_u32 m0, s60, 24576
    s_waitcnt vmcnt(15)
    buffer_load_dwordx4 v16, s[48:51], s63 offen offset:0 nt lds
    s_waitcnt vmcnt(24)
    v_lshlrev_b32 v56, 16, v104
    v_and_b32 v57, 0xffff0000, v104
    v_lshlrev_b32 v58, 16, v105
    v_and_b32 v59, 0xffff0000, v105
    v_fma_f32 v56, v56, s65, v30
    v_fma_f32 v57, v57, s65, v30
    v_fma_f32 v58, v58, s65, v30
    v_fma_f32 v59, v59, s65, v30
    v_exp_f32 v56, v56
    v_exp_f32 v57, v57
    v_exp_f32 v58, v58
    v_exp_f32 v59, v59
    s_nop 0
    v_cvt_pk_bf16_f32 v56, v56, v56
    v_cvt_pk_bf16_f32 v57, v57, v57
    v_cvt_pk_bf16_f32 v58, v58, v58
    v_cvt_pk_bf16_f32 v59, v59, v59
    s_add_u32 m0, s60, 24576
    s_waitcnt vmcnt(15)
    buffer_load_dwordx4 v16, s[48:51], s63 offen offset:2048 nt lds
    s_waitcnt vmcnt(16)
    ds_read_b128 v[64:67], v22 offset:0
    ds_read_b128 v[68:71], v22 offset:256
    ds_read_b128 v[72:75], v22 offset:2048
    ds_read_b128 v[76:79], v22 offset:2304
    ds_read_b128 v[80:83], v22 offset:4096
    ds_read_b128 v[84:87], v22 offset:4352
    ds_read_b128 v[88:91], v22 offset:6144
    ds_read_b128 v[92:95], v22 offset:6400
    v_and_b32 v32, v56, v24
    v_and_b32 v33, v56, v25
    v_and_b32 v34, v56, v26
    v_and_b32 v35, v56, v27
    v_and_b32 v36, v57, v24
    v_and_b32 v37, v57, v25
    v_and_b32 v38, v57, v26
    v_and_b32 v39, v57, v27
    v_and_b32 v40, v58, v24
    v_and_b32 v41, v58, v25
    v_and_b32 v42, v58, v26
    v_and_b32 v43, v58, v27
    v_and_b32 v44, v59, v24
    v_and_b32 v45, v59, v25
    v_and_b32 v46, v59, v26
    v_and_b32 v47, v59, v27
    s_waitcnt lgkmcnt(0)
    s_add_u32 m0, s60, 28672
    s_waitcnt vmcnt(15)
    buffer_load_dwordx4 v17, s[48:51], s63 offen offset:0 nt lds
    v_mfma_f32_16x16x32_bf16 v[48:51], v[32:35], v[64:67], v[48:51]
    v_mfma_f32_16x16x32_bf16 v[52:55], v[32:35], v[68:71], v[52:55]
    v_mfma_f32_16x16x32_bf16 v[48:51], v[36:39], v[72:75], v[48:51]
    v_mfma_f32_16x16x32_bf16 v[52:55], v[36:39], v[76:79], v[52:55]
    s_add_u32 m0, s60, 28672
    s_waitcnt vmcnt(15)
    buffer_load_dwordx4 v17, s[48:51], s63 offen offset:2048 nt lds
    v_mfma_f32_16x16x32_bf16 v[48:51], v[40:43], v[80:83], v[48:51]
    v_mfma_f32_16x16x32_bf16 v[52:55], v[40:43], v[84:87], v[52:55]
    v_mfma_f32_16x16x32_bf16 v[48:51], v[44:47], v[88:91], v[48:51]
    v_mfma_f32_16x16x32_bf16 v[52:55], v[44:47], v[92:95], v[52:55]
    s_mov_b32 s70, 1
    s_atomic_add s70, s[76:77], 0 glc
    s_add_u32 m0, s60, 24576
    s_waitcnt vmcnt(15)
    buffer_load_dwordx4 v16, s[48:51], s63 offen offset:1024 nt lds
    s_add_u32 m0, s60, 24576
    s_waitcnt vmcnt(15)
    buffer_load_dwordx4 v16, s[48:51], s63 offen offset:3072 nt lds
    s_add_u32 m0, s60, 28672
    s_waitcnt vmcnt(15)
    buffer_load_dwordx4 v17, s[48:51], s63 offen offset:1024 nt lds
    s_add_u32 m0, s60, 28672
    s_waitcnt vmcnt(15)
    buffer_load_dwordx4 v17, s[48:51], s63 offen offset:3072 nt lds
    s_waitcnt lgkmcnt(0)
    s_cmp_ge_u32 s70, 128
    s_cbranch_scc1 L_drain92
    s_and_b32 s5, s70, 31
    s_lshr_b32 s6, s70, 5
    s_lshl_b32 s7, s5, 10
    s_lshl_b32 s8, s6, 8
    s_add_u32 s72, s7, s8
    s_and_b32 s7, s2, 0
    s_or_b32 s5, s5, s7
    s_mul_i32 s7, s5, 0
    s_lshl_b32 s5, s5, 17
    s_add_u32 s5, s5, s78
    s_add_u32 s6, s6, s68
    s_bfe_u32 s4, s6, 0x30002
    s_lshl_b32 s4, s4, 22
    s_add_u32 s63, s5, s4
    s_add_u32 s4, s6, s7
    s_and_b32 s4, s4, 3
    s_lshl_b32 s4, s4, 15
    s_add_u32 s63, s63, s4
    s_add_u32 s4, s72, s9
    buffer_load_dwordx2 v[104:105], v103, s[56:59], s4 offen sc1
    s_add_u32 m0, s60, 0
    s_waitcnt vmcnt(15)
    buffer_load_dwordx4 v16, s[48:51], s63 offen offset:0 nt lds
    s_waitcnt vmcnt(24)
    v_lshlrev_b32 v56, 16, v106
    v_and_b32 v57, 0xffff0000, v106
    v_lshlrev_b32 v58, 16, v107
    v_and_b32 v59, 0xffff0000, v107
    v_fma_f32 v56, v56, s65, v30
    v_fma_f32 v57, v57, s65, v30
    v_fma_f32 v58, v58, s65, v30
    v_fma_f32 v59, v59, s65, v30
    v_exp_f32 v56, v56
    v_exp_f32 v57, v57
    v_exp_f32 v58, v58
    v_exp_f32 v59, v59
    s_nop 0
    v_cvt_pk_bf16_f32 v56, v56, v56
    v_cvt_pk_bf16_f32 v57, v57, v57
    v_cvt_pk_bf16_f32 v58, v58, v58
    v_cvt_pk_bf16_f32 v59, v59, v59
    s_add_u32 m0, s60, 0
    s_waitcnt vmcnt(15)
    buffer_load_dwordx4 v16, s[48:51], s63 offen offset:2048 nt lds
    s_waitcnt vmcnt(16)
    ds_read_b128 v[64:67], v22 offset:8192
    ds_read_b128 v[68:71], v22 offset:8448
    ds_read_b128 v[72:75], v22 offset:10240
    ds_read_b128 v[76:79], v22 offset:10496
    ds_read_b128 v[80:83], v22 offset:12288
    ds_read_b128 v[84:87], v22 offset:12544
    ds_read_b128 v[88:91], v22 offset:14336
    ds_read_b128 v[92:95], v22 offset:14592
    v_and_b32 v32, v56, v24
    v_and_b32 v33, v56, v25
    v_and_b32 v34, v56, v26
    v_and_b32 v35, v56, v27
    v_and_b32 v36, v57, v24
    v_and_b32 v37, v57, v25
    v_and_b32 v38, v57, v26
    v_and_b32 v39, v57, v27
    v_and_b32 v40, v58, v24
    v_and_b32 v41, v58, v25
    v_and_b32 v42, v58, v26
    v_and_b32 v43, v58, v27
    v_and_b32 v44, v59, v24
    v_and_b32 v45, v59, v25
    v_and_b32 v46, v59, v26
    v_and_b32 v47, v59, v27
    s_waitcnt lgkmcnt(0)
    s_add_u32 m0, s60, 4096
    s_waitcnt vmcnt(15)
    buffer_load_dwordx4 v17, s[48:51], s63 offen offset:0 nt lds
    v_mfma_f32_16x16x32_bf16 v[48:51], v[32:35], v[64:67], v[48:51]
    v_mfma_f32_16x16x32_bf16 v[52:55], v[32:35], v[68:71], v[52:55]
    v_mfma_f32_16x16x32_bf16 v[48:51], v[36:39], v[72:75], v[48:51]
    v_mfma_f32_16x16x32_bf16 v[52:55], v[36:39], v[76:79], v[52:55]
    s_add_u32 m0, s60, 4096
    s_waitcnt vmcnt(15)
    buffer_load_dwordx4 v17, s[48:51], s63 offen offset:2048 nt lds
    v_mfma_f32_16x16x32_bf16 v[48:51], v[40:43], v[80:83], v[48:51]
    v_mfma_f32_16x16x32_bf16 v[52:55], v[40:43], v[84:87], v[52:55]
    v_mfma_f32_16x16x32_bf16 v[48:51], v[44:47], v[88:91], v[48:51]
    v_mfma_f32_16x16x32_bf16 v[52:55], v[44:47], v[92:95], v[52:55]
    s_mov_b32 s70, 1
    s_atomic_add s70, s[76:77], 0 glc
    s_add_u32 m0, s60, 0
    s_waitcnt vmcnt(15)
    buffer_load_dwordx4 v16, s[48:51], s63 offen offset:1024 nt lds
    s_add_u32 m0, s60, 0
    s_waitcnt vmcnt(15)
    buffer_load_dwordx4 v16, s[48:51], s63 offen offset:3072 nt lds
    s_add_u32 m0, s60, 4096
    s_waitcnt vmcnt(15)
    buffer_load_dwordx4 v17, s[48:51], s63 offen offset:1024 nt lds
    s_add_u32 m0, s60, 4096
    s_waitcnt vmcnt(15)
    buffer_load_dwordx4 v17, s[48:51], s63 offen offset:3072 nt lds
    s_waitcnt lgkmcnt(0)
    s_cmp_ge_u32 s70, 128
    s_cbranch_scc1 L_drain93
    s_and_b32 s5, s70, 31
    s_lshr_b32 s6, s70, 5
    s_lshl_b32 s7, s5, 10
    s_lshl_b32 s8, s6, 8
    s_add_u32 s73, s7, s8
    s_and_b32 s7, s2, 0
    s_or_b32 s5, s5, s7
    s_mul_i32 s7, s5, 0
    s_lshl_b32 s5, s5, 17
    s_add_u32 s5, s5, s78
    s_add_u32 s6, s6, s68
    s_bfe_u32 s4, s6, 0x30002
    s_lshl_b32 s4, s4, 22
    s_add_u32 s63, s5, s4
    s_add_u32 s4, s6, s7
    s_and_b32 s4, s4, 3
    s_lshl_b32 s4, s4, 15
    s_add_u32 s63, s63, s4
    s_add_u32 s4, s73, s9
    buffer_load_dwordx2 v[106:107], v103, s[56:59], s4 offen sc1
    s_add_u32 m0, s60, 8192
    s_waitcnt vmcnt(15)
    buffer_load_dwordx4 v16, s[48:51], s63 offen offset:0 nt lds
    s_waitcnt vmcnt(24)
    v_lshlrev_b32 v56, 16, v108
    v_and_b32 v57, 0xffff0000, v108
    v_lshlrev_b32 v58, 16, v109
    v_and_b32 v59, 0xffff0000, v109
    v_fma_f32 v56, v56, s65, v30
    v_fma_f32 v57, v57, s65, v30
    v_fma_f32 v58, v58, s65, v30
    v_fma_f32 v59, v59, s65, v30
    v_exp_f32 v56, v56
    v_exp_f32 v57, v57
    v_exp_f32 v58, v58
    v_exp_f32 v59, v59
    s_nop 0
    v_cvt_pk_bf16_f32 v56, v56, v56
    v_cvt_pk_bf16_f32 v57, v57, v57
    v_cvt_pk_bf16_f32 v58, v58, v58
    v_cvt_pk_bf16_f32 v59, v59, v59
    s_add_u32 m0, s60, 8192
    s_waitcnt vmcnt(15)
    buffer_load_dwordx4 v16, s[48:51], s63 offen offset:2048 nt lds
    s_waitcnt vmcnt(16)
    ds_read_b128 v[64:67], v22 offset:16384
    ds_read_b128 v[68:71], v22 offset:16640
    ds_read_b128 v[72:75], v22 offset:18432
    ds_read_b128 v[76:79], v22 offset:18688
    ds_read_b128 v[80:83], v22 offset:20480
    ds_read_b128 v[84:87], v22 offset:20736
    ds_read_b128 v[88:91], v22 offset:22528
    ds_read_b128 v[92:95], v22 offset:22784
    v_and_b32 v32, v56, v24
    v_and_b32 v33, v56, v25
    v_and_b32 v34, v56, v26
    v_and_b32 v35, v56, v27
    v_and_b32 v36, v57, v24
    v_and_b32 v37, v57, v25
    v_and_b32 v38, v57, v26
    v_and_b32 v39, v57, v27
    v_and_b32 v40, v58, v24
    v_and_b32 v41, v58, v25
    v_and_b32 v42, v58, v26
    v_and_b32 v43, v58, v27
    v_and_b32 v44, v59, v24
    v_and_b32 v45, v59, v25
    v_and_b32 v46, v59, v26
    v_and_b32 v47, v59, v27
    s_waitcnt lgkmcnt(0)
    s_add_u32 m0, s60, 12288
    s_waitcnt vmcnt(15)
    buffer_load_dwordx4 v17, s[48:51], s63 offen offset:0 nt lds
    v_mfma_f32_16x16x32_bf16 v[48:51], v[32:35], v[64:67], v[48:51]
    v_mfma_f32_16x16x32_bf16 v[52:55], v[32:35], v[68:71], v[52:55]
    v_mfma_f32_16x16x32_bf16 v[48:51], v[36:39], v[72:75], v[48:51]
    v_mfma_f32_16x16x32_bf16 v[52:55], v[36:39], v[76:79], v[52:55]
    s_add_u32 m0, s60, 12288
    s_waitcnt vmcnt(15)
    buffer_load_dwordx4 v17, s[48:51], s63 offen offset:2048 nt lds
    v_mfma_f32_16x16x32_bf16 v[48:51], v[40:43], v[80:83], v[48:51]
    v_mfma_f32_16x16x32_bf16 v[52:55], v[40:43], v[84:87], v[52:55]
    v_mfma_f32_16x16x32_bf16 v[48:51], v[44:47], v[88:91], v[48:51]
    v_mfma_f32_16x16x32_bf16 v[52:55], v[44:47], v[92:95], v[52:55]
    s_mov_b32 s70, 1
    s_atomic_add s70, s[76:77], 0 glc
    s_add_u32 m0, s60, 8192
    s_waitcnt vmcnt(15)
    buffer_load_dwordx4 v16, s[48:51], s63 offen offset:1024 nt lds
    s_add_u32 m0, s60, 8192
    s_waitcnt vmcnt(15)
    buffer_load_dwordx4 v16, s[48:51], s63 offen offset:3072 nt lds
    s_add_u32 m0, s60, 12288
    s_waitcnt vmcnt(15)
    buffer_load_dwordx4 v17, s[48:51], s63 offen offset:1024 nt lds
    s_add_u32 m0, s60, 12288
    s_waitcnt vmcnt(15)
    buffer_load_dwordx4 v17, s[48:51], s63 offen offset:3072 nt lds
    s_waitcnt lgkmcnt(0)
    s_cmp_ge_u32 s70, 128
    s_cbranch_scc1 L_drain94
    s_and_b32 s5, s70, 31
    s_lshr_b32 s6, s70, 5
    s_lshl_b32 s7, s5, 10
    s_lshl_b32 s8, s6, 8
    s_add_u32 s74, s7, s8
    s_and_b32 s7, s2, 0
    s_or_b32 s5, s5, s7
    s_mul_i32 s7, s5, 0
    s_lshl_b32 s5, s5, 17
    s_add_u32 s5, s5, s78
    s_add_u32 s6, s6, s68
    s_bfe_u32 s4, s6, 0x30002
    s_lshl_b32 s4, s4, 22
    s_add_u32 s63, s5, s4
    s_add_u32 s4, s6, s7
    s_and_b32 s4, s4, 3
    s_lshl_b32 s4, s4, 15
    s_add_u32 s63, s63, s4
    s_add_u32 s4, s74, s9
    buffer_load_dwordx2 v[108:109], v103, s[56:59], s4 offen sc1
    s_add_u32 m0, s60, 16384
    s_waitcnt vmcnt(15)
    buffer_load_dwordx4 v16, s[48:51], s63 offen offset:0 nt lds
    s_waitcnt vmcnt(24)
    v_lshlrev_b32 v56, 16, v110
    v_and_b32 v57, 0xffff0000, v110
    v_lshlrev_b32 v58, 16, v111
    v_and_b32 v59, 0xffff0000, v111
    v_fma_f32 v56, v56, s65, v30
    v_fma_f32 v57, v57, s65, v30
    v_fma_f32 v58, v58, s65, v30
    v_fma_f32 v59, v59, s65, v30
    v_exp_f32 v56, v56
    v_exp_f32 v57, v57
    v_exp_f32 v58, v58
    v_exp_f32 v59, v59
    s_nop 0
    v_cvt_pk_bf16_f32 v56, v56, v56
    v_cvt_pk_bf16_f32 v57, v57, v57
    v_cvt_pk_bf16_f32 v58, v58, v58
    v_cvt_pk_bf16_f32 v59, v59, v59
    s_add_u32 m0, s60, 16384
    s_waitcnt vmcnt(15)
    buffer_load_dwordx4 v16, s[48:51], s63 offen offset:2048 nt lds
    s_waitcnt vmcnt(16)
    ds_read_b128 v[64:67], v22 offset:24576
    ds_read_b128 v[68:71], v22 offset:24832
    ds_read_b128 v[72:75], v22 offset:26624
    ds_read_b128 v[76:79], v22 offset:26880
    ds_read_b128 v[80:83], v22 offset:28672
    ds_read_b128 v[84:87], v22 offset:28928
    ds_read_b128 v[88:91], v22 offset:30720
    ds_read_b128 v[92:95], v22 offset:30976
    v_and_b32 v32, v56, v24
    v_and_b32 v33, v56, v25
    v_and_b32 v34, v56, v26
    v_and_b32 v35, v56, v27
    v_and_b32 v36, v57, v24
    v_and_b32 v37, v57, v25
    v_and_b32 v38, v57, v26
    v_and_b32 v39, v57, v27
    v_and_b32 v40, v58, v24
    v_and_b32 v41, v58, v25
    v_and_b32 v42, v58, v26
    v_and_b32 v43, v58, v27
    v_and_b32 v44, v59, v24
    v_and_b32 v45, v59, v25
    v_and_b32 v46, v59, v26
    v_and_b32 v47, v59, v27
    s_waitcnt lgkmcnt(0)
    s_add_u32 m0, s60, 20480
    s_waitcnt vmcnt(15)
    buffer_load_dwordx4 v17, s[48:51], s63 offen offset:0 nt lds
    v_mfma_f32_16x16x32_bf16 v[48:51], v[32:35], v[64:67], v[48:51]
    v_mfma_f32_16x16x32_bf16 v[52:55], v[32:35], v[68:71], v[52:55]
    v_mfma_f32_16x16x32_bf16 v[48:51], v[36:39], v[72:75], v[48:51]
    v_mfma_f32_16x16x32_bf16 v[52:55], v[36:39], v[76:79], v[52:55]
    s_add_u32 m0, s60, 20480
    s_waitcnt vmcnt(15)
    buffer_load_dwordx4 v17, s[48:51], s63 offen offset:2048 nt lds
    v_mfma_f32_16x16x32_bf16 v[48:51], v[40:43], v[80:83], v[48:51]
    v_mfma_f32_16x16x32_bf16 v[52:55], v[40:43], v[84:87], v[52:55]
    v_mfma_f32_16x16x32_bf16 v[48:51], v[44:47], v[88:91], v[48:51]
    v_mfma_f32_16x16x32_bf16 v[52:55], v[44:47], v[92:95], v[52:55]
    s_mov_b32 s70, 1
    s_atomic_add s70, s[76:77], 0 glc
    s_add_u32 m0, s60, 16384
    s_waitcnt vmcnt(15)
    buffer_load_dwordx4 v16, s[48:51], s63 offen offset:1024 nt lds
    s_add_u32 m0, s60, 16384
    s_waitcnt vmcnt(15)
    buffer_load_dwordx4 v16, s[48:51], s63 offen offset:3072 nt lds
    s_add_u32 m0, s60, 20480
    s_waitcnt vmcnt(15)
    buffer_load_dwordx4 v17, s[48:51], s63 offen offset:1024 nt lds
    s_add_u32 m0, s60, 20480
    s_waitcnt vmcnt(15)
    buffer_load_dwordx4 v17, s[48:51], s63 offen offset:3072 nt lds
    s_branch L_ploop89
L_drain91:
    s_cmp_eq_u32 s72, -1
    s_cbranch_scc1 L_pend90
    s_waitcnt vmcnt(24)
    s_cmp_ge_i32 s71, 2
    s_cbranch_scc1 L_wy99
    s_waitcnt vmcnt(16)
    s_cmp_ge_i32 s71, 1
    s_cbranch_scc1 L_wy99
    s_waitcnt vmcnt(8)
L_wy99:
    v_lshlrev_b32 v56, 16, v104
    v_and_b32 v57, 0xffff0000, v104
    v_lshlrev_b32 v58, 16, v105
    v_and_b32 v59, 0xffff0000, v105
    v_fma_f32 v56, v56, s65, v30
    v_fma_f32 v57, v57, s65, v30
    v_fma_f32 v58, v58, s65, v30
    v_fma_f32 v59, v59, s65, v30
    v_exp_f32 v56, v56
    v_exp_f32 v57, v57
    v_exp_f32 v58, v58
    v_exp_f32 v59, v59
    s_nop 0
    v_cvt_pk_bf16_f32 v56, v56, v56
    v_cvt_pk_bf16_f32 v57, v57, v57
    v_cvt_pk_bf16_f32 v58, v58, v58
    v_cvt_pk_bf16_f32 v59, v59, v59
    v_and_b32 v32, v56, v24
    v_and_b32 v33, v56, v25
    v_and_b32 v34, v56, v26
    v_and_b32 v35, v56, v27
    v_and_b32 v36, v57, v24
    v_and_b32 v37, v57, v25
    v_and_b32 v38, v57, v26
    v_and_b32 v39, v57, v27
    v_and_b32 v40, v58, v24
    v_and_b32 v41, v58, v25
    v_and_b32 v42, v58, v26
    v_and_b32 v43, v58, v27
    v_and_b32 v44, v59, v24
    v_and_b32 v45, v59, v25
    v_and_b32 v46, v59, v26
    v_and_b32 v47, v59, v27
    s_waitcnt vmcnt(16)
    s_cmp_ge_i32 s71, 2
    s_cbranch_scc1 L_wy100
    s_waitcnt vmcnt(8)
    s_cmp_ge_i32 s71, 1
    s_cbranch_scc1 L_wy100
    s_waitcnt vmcnt(0)
L_wy100:
    ds_read_b128 v[64:67], v22 offset:0
    ds_read_b128 v[68:71], v22 offset:256
    ds_read_b128 v[72:75], v22 offset:2048
    ds_read_b128 v[76:79], v22 offset:2304
    ds_read_b128 v[80:83], v22 offset:4096
    ds_read_b128 v[84:87], v22 offset:4352
    ds_read_b128 v[88:91], v22 offset:6144
    ds_read_b128 v[92:95], v22 offset:6400
    s_waitcnt lgkmcnt(7)
    v_mfma_f32_16x16x32_bf16 v[48:51], v[32:35], v[64:67], v[48:51]
    s_waitcnt lgkmcnt(6)
    v_mfma_f32_16x16x32_bf16 v[52:55], v[32:35], v[68:71], v[52:55]
    s_waitcnt lgkmcnt(5)
    v_mfma_f32_16x16x32_bf16 v[48:51], v[36:39], v[72:75], v[48:51]
    s_waitcnt lgkmcnt(4)
    v_mfma_f32_16x16x32_bf16 v[52:55], v[36:39], v[76:79], v[52:55]
    s_waitcnt lgkmcnt(3)
    v_mfma_f32_16x16x32_bf16 v[48:51], v[40:43], v[80:83], v[48:51]
    s_waitcnt lgkmcnt(2)
    v_mfma_f32_16x16x32_bf16 v[52:55], v[40:43], v[84:87], v[52:55]
    s_waitcnt lgkmcnt(1)
    v_mfma_f32_16x16x32_bf16 v[48:51], v[44:47], v[88:91], v[48:51]
    s_waitcnt lgkmcnt(0)
    v_mfma_f32_16x16x32_bf16 v[52:55], v[44:47], v[92:95], v[52:55]
    s_sub_u32 s71, s71, 1
    s_cmp_eq_u32 s73, -1
    s_cbranch_scc1 L_pend90
    s_waitcnt vmcnt(24)
    s_cmp_ge_i32 s71, 2
    s_cbranch_scc1 L_wy101
    s_waitcnt vmcnt(16)
    s_cmp_ge_i32 s71, 1
    s_cbranch_scc1 L_wy101
    s_waitcnt vmcnt(8)
L_wy101:
    v_lshlrev_b32 v56, 16, v106
    v_and_b32 v57, 0xffff0000, v106
    v_lshlrev_b32 v58, 16, v107
    v_and_b32 v59, 0xffff0000, v107
    v_fma_f32 v56, v56, s65, v30
    v_fma_f32 v57, v57, s65, v30
    v_fma_f32 v58, v58, s65, v30
    v_fma_f32 v59, v59, s65, v30
    v_exp_f32 v56, v56
    v_exp_f32 v57, v57
    v_exp_f32 v58, v58
    v_exp_f32 v59, v59
    s_nop 0
    v_cvt_pk_bf16_f32 v56, v56, v56
    v_cvt_pk_bf16_f32 v57, v57, v57
    v_cvt_pk_bf16_f32 v58, v58, v58
    v_cvt_pk_bf16_f32 v59, v59, v59
    v_and_b32 v32, v56, v24
    v_and_b32 v33, v56, v25
    v_and_b32 v34, v56, v26
    v_and_b32 v35, v56, v27
    v_and_b32 v36, v57, v24
    v_and_b32 v37, v57, v25
    v_and_b32 v38, v57, v26
    v_and_b32 v39, v57, v27
    v_and_b32 v40, v58, v24
    v_and_b32 v41, v58, v25
    v_and_b32 v42, v58, v26
    v_and_b32 v43, v58, v27
    v_and_b32 v44, v59, v24
    v_and_b32 v45, v59, v25
    v_and_b32 v46, v59, v26
    v_and_b32 v47, v59, v27
    s_waitcnt vmcnt(16)
    s_cmp_ge_i32 s71, 2
    s_cbranch_scc1 L_wy102
    s_waitcnt vmcnt(8)
    s_cmp_ge_i32 s71, 1
    s_cbranch_scc1 L_wy102
    s_waitcnt vmcnt(0)
L_wy102:
    ds_read_b128 v[64:67], v22 offset:8192
    ds_read_b128 v[68:71], v22 offset:8448
    ds_read_b128 v[72:75], v22 offset:10240
    ds_read_b128 v[76:79], v22 offset:10496
    ds_read_b128 v[80:83], v22 offset:12288
    ds_read_b128 v[84:87], v22 offset:12544
    ds_read_b128 v[88:91], v22 offset:14336
    ds_read_b128 v[92:95], v22 offset:14592
    s_waitcnt lgkmcnt(7)
    v_mfma_f32_16x16x32_bf16 v[48:51], v[32:35], v[64:67], v[48:51]
    s_waitcnt lgkmcnt(6)
    v_mfma_f32_16x16x32_bf16 v[52:55], v[32:35], v[68:71], v[52:55]
    s_waitcnt lgkmcnt(5)
    v_mfma_f32_16x16x32_bf16 v[48:51], v[36:39], v[72:75], v[48:51]
    s_waitcnt lgkmcnt(4)
    v_mfma_f32_16x16x32_bf16 v[52:55], v[36:39], v[76:79], v[52:55]
    s_waitcnt lgkmcnt(3)
    v_mfma_f32_16x16x32_bf16 v[48:51], v[40:43], v[80:83], v[48:51]
    s_waitcnt lgkmcnt(2)
    v_mfma_f32_16x16x32_bf16 v[52:55], v[40:43], v[84:87], v[52:55]
    s_waitcnt lgkmcnt(1)
    v_mfma_f32_16x16x32_bf16 v[48:51], v[44:47], v[88:91], v[48:51]
    s_waitcnt lgkmcnt(0)
    v_mfma_f32_16x16x32_bf16 v[52:55], v[44:47], v[92:95], v[52:55]
    s_sub_u32 s71, s71, 1
    s_cmp_eq_u32 s74, -1
    s_cbranch_scc1 L_pend90
    s_waitcnt vmcnt(24)
    s_cmp_ge_i32 s71, 2
    s_cbranch_scc1 L_wy103
    s_waitcnt vmcnt(16)
    s_cmp_ge_i32 s71, 1
    s_cbranch_scc1 L_wy103
    s_waitcnt vmcnt(8)
L_wy103:
    v_lshlrev_b32 v56, 16, v108
    v_and_b32 v57, 0xffff0000, v108
    v_lshlrev_b32 v58, 16, v109
    v_and_b32 v59, 0xffff0000, v109
    v_fma_f32 v56, v56, s65, v30
    v_fma_f32 v57, v57, s65, v30
    v_fma_f32 v58, v58, s65, v30
    v_fma_f32 v59, v59, s65, v30
    v_exp_f32 v56, v56
    v_exp_f32 v57, v57
    v_exp_f32 v58, v58
    v_exp_f32 v59, v59
    s_nop 0
    v_cvt_pk_bf16_f32 v56, v56, v56
    v_cvt_pk_bf16_f32 v57, v57, v57
    v_cvt_pk_bf16_f32 v58, v58, v58
    v_cvt_pk_bf16_f32 v59, v59, v59
    v_and_b32 v32, v56, v24
    v_and_b32 v33, v56, v25
    v_and_b32 v34, v56, v26
    v_and_b32 v35, v56, v27
    v_and_b32 v36, v57, v24
    v_and_b32 v37, v57, v25
    v_and_b32 v38, v57, v26
    v_and_b32 v39, v57, v27
    v_and_b32 v40, v58, v24
    v_and_b32 v41, v58, v25
    v_and_b32 v42, v58, v26
    v_and_b32 v43, v58, v27
    v_and_b32 v44, v59, v24
    v_and_b32 v45, v59, v25
    v_and_b32 v46, v59, v26
    v_and_b32 v47, v59, v27
    s_waitcnt vmcnt(16)
    s_cmp_ge_i32 s71, 2
    s_cbranch_scc1 L_wy104
    s_waitcnt vmcnt(8)
    s_cmp_ge_i32 s71, 1
    s_cbranch_scc1 L_wy104
    s_waitcnt vmcnt(0)
L_wy104:
    ds_read_b128 v[64:67], v22 offset:16384
    ds_read_b128 v[68:71], v22 offset:16640
    ds_read_b128 v[72:75], v22 offset:18432
    ds_read_b128 v[76:79], v22 offset:18688
    ds_read_b128 v[80:83], v22 offset:20480
    ds_read_b128 v[84:87], v22 offset:20736
    ds_read_b128 v[88:91], v22 offset:22528
    ds_read_b128 v[92:95], v22 offset:22784
    s_waitcnt lgkmcnt(7)
    v_mfma_f32_16x16x32_bf16 v[48:51], v[32:35], v[64:67], v[48:51]
    s_waitcnt lgkmcnt(6)
    v_mfma_f32_16x16x32_bf16 v[52:55], v[32:35], v[68:71], v[52:55]
    s_waitcnt lgkmcnt(5)
    v_mfma_f32_16x16x32_bf16 v[48:51], v[36:39], v[72:75], v[48:51]
    s_waitcnt lgkmcnt(4)
    v_mfma_f32_16x16x32_bf16 v[52:55], v[36:39], v[76:79], v[52:55]
    s_waitcnt lgkmcnt(3)
    v_mfma_f32_16x16x32_bf16 v[48:51], v[40:43], v[80:83], v[48:51]
    s_waitcnt lgkmcnt(2)
    v_mfma_f32_16x16x32_bf16 v[52:55], v[40:43], v[84:87], v[52:55]
    s_waitcnt lgkmcnt(1)
    v_mfma_f32_16x16x32_bf16 v[48:51], v[44:47], v[88:91], v[48:51]
    s_waitcnt lgkmcnt(0)
    v_mfma_f32_16x16x32_bf16 v[52:55], v[44:47], v[92:95], v[52:55]
    s_branch L_pend90
L_drain92:
    s_cmp_eq_u32 s73, -1
    s_cbranch_scc1 L_pend90
    s_waitcnt vmcnt(24)
    s_cmp_ge_i32 s71, 2
    s_cbranch_scc1 L_wy105
    s_waitcnt vmcnt(16)
    s_cmp_ge_i32 s71, 1
    s_cbranch_scc1 L_wy105
    s_waitcnt vmcnt(8)
L_wy105:
    v_lshlrev_b32 v56, 16, v106
    v_and_b32 v57, 0xffff0000, v106
    v_lshlrev_b32 v58, 16, v107
    v_and_b32 v59, 0xffff0000, v107
    v_fma_f32 v56, v56, s65, v30
    v_fma_f32 v57, v57, s65, v30
    v_fma_f32 v58, v58, s65, v30
    v_fma_f32 v59, v59, s65, v30
    v_exp_f32 v56, v56
    v_exp_f32 v57, v57
    v_exp_f32 v58, v58
    v_exp_f32 v59, v59
    s_nop 0
    v_cvt_pk_bf16_f32 v56, v56, v56
    v_cvt_pk_bf16_f32 v57, v57, v57
    v_cvt_pk_bf16_f32 v58, v58, v58
    v_cvt_pk_bf16_f32 v59, v59, v59
    v_and_b32 v32, v56, v24
    v_and_b32 v33, v56, v25
    v_and_b32 v34, v56, v26
    v_and_b32 v35, v56, v27
    v_and_b32 v36, v57, v24
    v_and_b32 v37, v57, v25
    v_and_b32 v38, v57, v26
    v_and_b32 v39, v57, v27
    v_and_b32 v40, v58, v24
    v_and_b32 v41, v58, v25
    v_and_b32 v42, v58, v26
    v_and_b32 v43, v58, v27
    v_and_b32 v44, v59, v24
    v_and_b32 v45, v59, v25
    v_and_b32 v46, v59, v26
    v_and_b32 v47, v59, v27
    s_waitcnt vmcnt(16)
    s_cmp_ge_i32 s71, 2
    s_cbranch_scc1 L_wy106
    s_waitcnt vmcnt(8)
    s_cmp_ge_i32 s71, 1
    s_cbranch_scc1 L_wy106
    s_waitcnt vmcnt(0)
L_wy106:
    ds_read_b128 v[64:67], v22 offset:8192
    ds_read_b128 v[68:71], v22 offset:8448
    ds_read_b128 v[72:75], v22 offset:10240
    ds_read_b128 v[76:79], v22 offset:10496
    ds_read_b128 v[80:83], v22 offset:12288
    ds_read_b128 v[84:87], v22 offset:12544
    ds_read_b128 v[88:91], v22 offset:14336
    ds_read_b128 v[92:95], v22 offset:14592
    s_waitcnt lgkmcnt(7)
    v_mfma_f32_16x16x32_bf16 v[48:51], v[32:35], v[64:67], v[48:51]
    s_waitcnt lgkmcnt(6)
    v_mfma_f32_16x16x32_bf16 v[52:55], v[32:35], v[68:71], v[52:55]
    s_waitcnt lgkmcnt(5)
    v_mfma_f32_16x16x32_bf16 v[48:51], v[36:39], v[72:75], v[48:51]
    s_waitcnt lgkmcnt(4)
    v_mfma_f32_16x16x32_bf16 v[52:55], v[36:39], v[76:79], v[52:55]
    s_waitcnt lgkmcnt(3)
    v_mfma_f32_16x16x32_bf16 v[48:51], v[40:43], v[80:83], v[48:51]
    s_waitcnt lgkmcnt(2)
    v_mfma_f32_16x16x32_bf16 v[52:55], v[40:43], v[84:87], v[52:55]
    s_waitcnt lgkmcnt(1)
    v_mfma_f32_16x16x32_bf16 v[48:51], v[44:47], v[88:91], v[48:51]
    s_waitcnt lgkmcnt(0)
    v_mfma_f32_16x16x32_bf16 v[52:55], v[44:47], v[92:95], v[52:55]
    s_sub_u32 s71, s71, 1
    s_cmp_eq_u32 s74, -1
    s_cbranch_scc1 L_pend90
    s_waitcnt vmcnt(24)
    s_cmp_ge_i32 s71, 2
    s_cbranch_scc1 L_wy107
    s_waitcnt vmcnt(16)
    s_cmp_ge_i32 s71, 1
    s_cbranch_scc1 L_wy107
    s_waitcnt vmcnt(8)
L_wy107:
    v_lshlrev_b32 v56, 16, v108
    v_and_b32 v57, 0xffff0000, v108
    v_lshlrev_b32 v58, 16, v109
    v_and_b32 v59, 0xffff0000, v109
    v_fma_f32 v56, v56, s65, v30
    v_fma_f32 v57, v57, s65, v30
    v_fma_f32 v58, v58, s65, v30
    v_fma_f32 v59, v59, s65, v30
    v_exp_f32 v56, v56
    v_exp_f32 v57, v57
    v_exp_f32 v58, v58
    v_exp_f32 v59, v59
    s_nop 0
    v_cvt_pk_bf16_f32 v56, v56, v56
    v_cvt_pk_bf16_f32 v57, v57, v57
    v_cvt_pk_bf16_f32 v58, v58, v58
    v_cvt_pk_bf16_f32 v59, v59, v59
    v_and_b32 v32, v56, v24
    v_and_b32 v33, v56, v25
    v_and_b32 v34, v56, v26
    v_and_b32 v35, v56, v27
    v_and_b32 v36, v57, v24
    v_and_b32 v37, v57, v25
    v_and_b32 v38, v57, v26
    v_and_b32 v39, v57, v27
    v_and_b32 v40, v58, v24
    v_and_b32 v41, v58, v25
    v_and_b32 v42, v58, v26
    v_and_b32 v43, v58, v27
    v_and_b32 v44, v59, v24
    v_and_b32 v45, v59, v25
    v_and_b32 v46, v59, v26
    v_and_b32 v47, v59, v27
    s_waitcnt vmcnt(16)
    s_cmp_ge_i32 s71, 2
    s_cbranch_scc1 L_wy108
    s_waitcnt vmcnt(8)
    s_cmp_ge_i32 s71, 1
    s_cbranch_scc1 L_wy108
    s_waitcnt vmcnt(0)
L_wy108:
    ds_read_b128 v[64:67], v22 offset:16384
    ds_read_b128 v[68:71], v22 offset:16640
    ds_read_b128 v[72:75], v22 offset:18432
    ds_read_b128 v[76:79], v22 offset:18688
    ds_read_b128 v[80:83], v22 offset:20480
    ds_read_b128 v[84:87], v22 offset:20736
    ds_read_b128 v[88:91], v22 offset:22528
    ds_read_b128 v[92:95], v22 offset:22784
    s_waitcnt lgkmcnt(7)
    v_mfma_f32_16x16x32_bf16 v[48:51], v[32:35], v[64:67], v[48:51]
    s_waitcnt lgkmcnt(6)
    v_mfma_f32_16x16x32_bf16 v[52:55], v[32:35], v[68:71], v[52:55]
    s_waitcnt lgkmcnt(5)
    v_mfma_f32_16x16x32_bf16 v[48:51], v[36:39], v[72:75], v[48:51]
    s_waitcnt lgkmcnt(4)
    v_mfma_f32_16x16x32_bf16 v[52:55], v[36:39], v[76:79], v[52:55]
    s_waitcnt lgkmcnt(3)
    v_mfma_f32_16x16x32_bf16 v[48:51], v[40:43], v[80:83], v[48:51]
    s_waitcnt lgkmcnt(2)
    v_mfma_f32_16x16x32_bf16 v[52:55], v[40:43], v[84:87], v[52:55]
    s_waitcnt lgkmcnt(1)
    v_mfma_f32_16x16x32_bf16 v[48:51], v[44:47], v[88:91], v[48:51]
    s_waitcnt lgkmcnt(0)
    v_mfma_f32_16x16x32_bf16 v[52:55], v[44:47], v[92:95], v[52:55]
    s_sub_u32 s71, s71, 1
    s_cmp_eq_u32 s75, -1
    s_cbranch_scc1 L_pend90
    s_waitcnt vmcnt(24)
    s_cmp_ge_i32 s71, 2
    s_cbranch_scc1 L_wy109
    s_waitcnt vmcnt(16)
    s_cmp_ge_i32 s71, 1
    s_cbranch_scc1 L_wy109
    s_waitcnt vmcnt(8)
L_wy109:
    v_lshlrev_b32 v56, 16, v110
    v_and_b32 v57, 0xffff0000, v110
    v_lshlrev_b32 v58, 16, v111
    v_and_b32 v59, 0xffff0000, v111
    v_fma_f32 v56, v56, s65, v30
    v_fma_f32 v57, v57, s65, v30
    v_fma_f32 v58, v58, s65, v30
    v_fma_f32 v59, v59, s65, v30
    v_exp_f32 v56, v56
    v_exp_f32 v57, v57
    v_exp_f32 v58, v58
    v_exp_f32 v59, v59
    s_nop 0
    v_cvt_pk_bf16_f32 v56, v56, v56
    v_cvt_pk_bf16_f32 v57, v57, v57
    v_cvt_pk_bf16_f32 v58, v58, v58
    v_cvt_pk_bf16_f32 v59, v59, v59
    v_and_b32 v32, v56, v24
    v_and_b32 v33, v56, v25
    v_and_b32 v34, v56, v26
    v_and_b32 v35, v56, v27
    v_and_b32 v36, v57, v24
    v_and_b32 v37, v57, v25
    v_and_b32 v38, v57, v26
    v_and_b32 v39, v57, v27
    v_and_b32 v40, v58, v24
    v_and_b32 v41, v58, v25
    v_and_b32 v42, v58, v26
    v_and_b32 v43, v58, v27
    v_and_b32 v44, v59, v24
    v_and_b32 v45, v59, v25
    v_and_b32 v46, v59, v26
    v_and_b32 v47, v59, v27
    s_waitcnt vmcnt(16)
    s_cmp_ge_i32 s71, 2
    s_cbranch_scc1 L_wy110
    s_waitcnt vmcnt(8)
    s_cmp_ge_i32 s71, 1
    s_cbranch_scc1 L_wy110
    s_waitcnt vmcnt(0)
L_wy110:
    ds_read_b128 v[64:67], v22 offset:24576
    ds_read_b128 v[68:71], v22 offset:24832
    ds_read_b128 v[72:75], v22 offset:26624
    ds_read_b128 v[76:79], v22 offset:26880
    ds_read_b128 v[80:83], v22 offset:28672
    ds_read_b128 v[84:87], v22 offset:28928
    ds_read_b128 v[88:91], v22 offset:30720
    ds_read_b128 v[92:95], v22 offset:30976
    s_waitcnt lgkmcnt(7)
    v_mfma_f32_16x16x32_bf16 v[48:51], v[32:35], v[64:67], v[48:51]
    s_waitcnt lgkmcnt(6)
    v_mfma_f32_16x16x32_bf16 v[52:55], v[32:35], v[68:71], v[52:55]
    s_waitcnt lgkmcnt(5)
    v_mfma_f32_16x16x32_bf16 v[48:51], v[36:39], v[72:75], v[48:51]
    s_waitcnt lgkmcnt(4)
    v_mfma_f32_16x16x32_bf16 v[52:55], v[36:39], v[76:79], v[52:55]
    s_waitcnt lgkmcnt(3)
    v_mfma_f32_16x16x32_bf16 v[48:51], v[40:43], v[80:83], v[48:51]
    s_waitcnt lgkmcnt(2)
    v_mfma_f32_16x16x32_bf16 v[52:55], v[40:43], v[84:87], v[52:55]
    s_waitcnt lgkmcnt(1)
    v_mfma_f32_16x16x32_bf16 v[48:51], v[44:47], v[88:91], v[48:51]
    s_waitcnt lgkmcnt(0)
    v_mfma_f32_16x16x32_bf16 v[52:55], v[44:47], v[92:95], v[52:55]
    s_branch L_pend90
L_drain93:
    s_cmp_eq_u32 s74, -1
    s_cbranch_scc1 L_pend90
    s_waitcnt vmcnt(24)
    s_cmp_ge_i32 s71, 2
    s_cbranch_scc1 L_wy111
    s_waitcnt vmcnt(16)
    s_cmp_ge_i32 s71, 1
    s_cbranch_scc1 L_wy111
    s_waitcnt vmcnt(8)
L_wy111:
    v_lshlrev_b32 v56, 16, v108
    v_and_b32 v57, 0xffff0000, v108
    v_lshlrev_b32 v58, 16, v109
    v_and_b32 v59, 0xffff0000, v109
    v_fma_f32 v56, v56, s65, v30
    v_fma_f32 v57, v57, s65, v30
    v_fma_f32 v58, v58, s65, v30
    v_fma_f32 v59, v59, s65, v30
    v_exp_f32 v56, v56
    v_exp_f32 v57, v57
    v_exp_f32 v58, v58
    v_exp_f32 v59, v59
    s_nop 0
    v_cvt_pk_bf16_f32 v56, v56, v56
    v_cvt_pk_bf16_f32 v57, v57, v57
    v_cvt_pk_bf16_f32 v58, v58, v58
    v_cvt_pk_bf16_f32 v59, v59, v59
    v_and_b32 v32, v56, v24
    v_and_b32 v33, v56, v25
    v_and_b32 v34, v56, v26
    v_and_b32 v35, v56, v27
    v_and_b32 v36, v57, v24
    v_and_b32 v37, v57, v25
    v_and_b32 v38, v57, v26
    v_and_b32 v39, v57, v27
    v_and_b32 v40, v58, v24
    v_and_b32 v41, v58, v25
    v_and_b32 v42, v58, v26
    v_and_b32 v43, v58, v27
    v_and_b32 v44, v59, v24
    v_and_b32 v45, v59, v25
    v_and_b32 v46, v59, v26
    v_and_b32 v47, v59, v27
    s_waitcnt vmcnt(16)
    s_cmp_ge_i32 s71, 2
    s_cbranch_scc1 L_wy112
    s_waitcnt vmcnt(8)
    s_cmp_ge_i32 s71, 1
    s_cbranch_scc1 L_wy112
    s_waitcnt vmcnt(0)
L_wy112:
    ds_read_b128 v[64:67], v22 offset:16384
    ds_read_b128 v[68:71], v22 offset:16640
    ds_read_b128 v[72:75], v22 offset:18432
    ds_read_b128 v[76:79], v22 offset:18688
    ds_read_b128 v[80:83], v22 offset:20480
    ds_read_b128 v[84:87], v22 offset:20736
    ds_read_b128 v[88:91], v22 offset:22528
    ds_read_b128 v[92:95], v22 offset:22784
    s_waitcnt lgkmcnt(7)
    v_mfma_f32_16x16x32_bf16 v[48:51], v[32:35], v[64:67], v[48:51]
    s_waitcnt lgkmcnt(6)
    v_mfma_f32_16x16x32_bf16 v[52:55], v[32:35], v[68:71], v[52:55]
    s_waitcnt lgkmcnt(5)
    v_mfma_f32_16x16x32_bf16 v[48:51], v[36:39], v[72:75], v[48:51]
    s_waitcnt lgkmcnt(4)
    v_mfma_f32_16x16x32_bf16 v[52:55], v[36:39], v[76:79], v[52:55]
    s_waitcnt lgkmcnt(3)
    v_mfma_f32_16x16x32_bf16 v[48:51], v[40:43], v[80:83], v[48:51]
    s_waitcnt lgkmcnt(2)
    v_mfma_f32_16x16x32_bf16 v[52:55], v[40:43], v[84:87], v[52:55]
    s_waitcnt lgkmcnt(1)
    v_mfma_f32_16x16x32_bf16 v[48:51], v[44:47], v[88:91], v[48:51]
    s_waitcnt lgkmcnt(0)
    v_mfma_f32_16x16x32_bf16 v[52:55], v[44:47], v[92:95], v[52:55]
    s_sub_u32 s71, s71, 1
    s_cmp_eq_u32 s75, -1
    s_cbranch_scc1 L_pend90
    s_waitcnt vmcnt(24)
    s_cmp_ge_i32 s71, 2
    s_cbranch_scc1 L_wy113
    s_waitcnt vmcnt(16)
    s_cmp_ge_i32 s71, 1
    s_cbranch_scc1 L_wy113
    s_waitcnt vmcnt(8)
L_wy113:
    v_lshlrev_b32 v56, 16, v110
    v_and_b32 v57, 0xffff0000, v110
    v_lshlrev_b32 v58, 16, v111
    v_and_b32 v59, 0xffff0000, v111
    v_fma_f32 v56, v56, s65, v30
    v_fma_f32 v57, v57, s65, v30
    v_fma_f32 v58, v58, s65, v30
    v_fma_f32 v59, v59, s65, v30
    v_exp_f32 v56, v56
    v_exp_f32 v57, v57
    v_exp_f32 v58, v58
    v_exp_f32 v59, v59
    s_nop 0
    v_cvt_pk_bf16_f32 v56, v56, v56
    v_cvt_pk_bf16_f32 v57, v57, v57
    v_cvt_pk_bf16_f32 v58, v58, v58
    v_cvt_pk_bf16_f32 v59, v59, v59
    v_and_b32 v32, v56, v24
    v_and_b32 v33, v56, v25
    v_and_b32 v34, v56, v26
    v_and_b32 v35, v56, v27
    v_and_b32 v36, v57, v24
    v_and_b32 v37, v57, v25
    v_and_b32 v38, v57, v26
    v_and_b32 v39, v57, v27
    v_and_b32 v40, v58, v24
    v_and_b32 v41, v58, v25
    v_and_b32 v42, v58, v26
    v_and_b32 v43, v58, v27
    v_and_b32 v44, v59, v24
    v_and_b32 v45, v59, v25
    v_and_b32 v46, v59, v26
    v_and_b32 v47, v59, v27
    s_waitcnt vmcnt(16)
    s_cmp_ge_i32 s71, 2
    s_cbranch_scc1 L_wy114
    s_waitcnt vmcnt(8)
    s_cmp_ge_i32 s71, 1
    s_cbranch_scc1 L_wy114
    s_waitcnt vmcnt(0)
L_wy114:
    ds_read_b128 v[64:67], v22 offset:24576
    ds_read_b128 v[68:71], v22 offset:24832
    ds_read_b128 v[72:75], v22 offset:26624
    ds_read_b128 v[76:79], v22 offset:26880
    ds_read_b128 v[80:83], v22 offset:28672
    ds_read_b128 v[84:87], v22 offset:28928
    ds_read_b128 v[88:91], v22 offset:30720
    ds_read_b128 v[92:95], v22 offset:30976
    s_waitcnt lgkmcnt(7)
    v_mfma_f32_16x16x32_bf16 v[48:51], v[32:35], v[64:67], v[48:51]
    s_waitcnt lgkmcnt(6)
    v_mfma_f32_16x16x32_bf16 v[52:55], v[32:35], v[68:71], v[52:55]
    s_waitcnt lgkmcnt(5)
    v_mfma_f32_16x16x32_bf16 v[48:51], v[36:39], v[72:75], v[48:51]
    s_waitcnt lgkmcnt(4)
    v_mfma_f32_16x16x32_bf16 v[52:55], v[36:39], v[76:79], v[52:55]
    s_waitcnt lgkmcnt(3)
    v_mfma_f32_16x16x32_bf16 v[48:51], v[40:43], v[80:83], v[48:51]
    s_waitcnt lgkmcnt(2)
    v_mfma_f32_16x16x32_bf16 v[52:55], v[40:43], v[84:87], v[52:55]
    s_waitcnt lgkmcnt(1)
    v_mfma_f32_16x16x32_bf16 v[48:51], v[44:47], v[88:91], v[48:51]
    s_waitcnt lgkmcnt(0)
    v_mfma_f32_16x16x32_bf16 v[52:55], v[44:47], v[92:95], v[52:55]
    s_sub_u32 s71, s71, 1
    s_cmp_eq_u32 s72, -1
    s_cbranch_scc1 L_pend90
    s_waitcnt vmcnt(24)
    s_cmp_ge_i32 s71, 2
    s_cbranch_scc1 L_wy115
    s_waitcnt vmcnt(16)
    s_cmp_ge_i32 s71, 1
    s_cbranch_scc1 L_wy115
    s_waitcnt vmcnt(8)
L_wy115:
    v_lshlrev_b32 v56, 16, v104
    v_and_b32 v57, 0xffff0000, v104
    v_lshlrev_b32 v58, 16, v105
    v_and_b32 v59, 0xffff0000, v105
    v_fma_f32 v56, v56, s65, v30
    v_fma_f32 v57, v57, s65, v30
    v_fma_f32 v58, v58, s65, v30
    v_fma_f32 v59, v59, s65, v30
    v_exp_f32 v56, v56
    v_exp_f32 v57, v57
    v_exp_f32 v58, v58
    v_exp_f32 v59, v59
    s_nop 0
    v_cvt_pk_bf16_f32 v56, v56, v56
    v_cvt_pk_bf16_f32 v57, v57, v57
    v_cvt_pk_bf16_f32 v58, v58, v58
    v_cvt_pk_bf16_f32 v59, v59, v59
    v_and_b32 v32, v56, v24
    v_and_b32 v33, v56, v25
    v_and_b32 v34, v56, v26
    v_and_b32 v35, v56, v27
    v_and_b32 v36, v57, v24
    v_and_b32 v37, v57, v25
    v_and_b32 v38, v57, v26
    v_and_b32 v39, v57, v27
    v_and_b32 v40, v58, v24
    v_and_b32 v41, v58, v25
    v_and_b32 v42, v58, v26
    v_and_b32 v43, v58, v27
    v_and_b32 v44, v59, v24
    v_and_b32 v45, v59, v25
    v_and_b32 v46, v59, v26
    v_and_b32 v47, v59, v27
    s_waitcnt vmcnt(16)
    s_cmp_ge_i32 s71, 2
    s_cbranch_scc1 L_wy116
    s_waitcnt vmcnt(8)
    s_cmp_ge_i32 s71, 1
    s_cbranch_scc1 L_wy116
    s_waitcnt vmcnt(0)
L_wy116:
    ds_read_b128 v[64:67], v22 offset:0
    ds_read_b128 v[68:71], v22 offset:256
    ds_read_b128 v[72:75], v22 offset:2048
    ds_read_b128 v[76:79], v22 offset:2304
    ds_read_b128 v[80:83], v22 offset:4096
    ds_read_b128 v[84:87], v22 offset:4352
    ds_read_b128 v[88:91], v22 offset:6144
    ds_read_b128 v[92:95], v22 offset:6400
    s_waitcnt lgkmcnt(7)
    v_mfma_f32_16x16x32_bf16 v[48:51], v[32:35], v[64:67], v[48:51]
    s_waitcnt lgkmcnt(6)
    v_mfma_f32_16x16x32_bf16 v[52:55], v[32:35], v[68:71], v[52:55]
    s_waitcnt lgkmcnt(5)
    v_mfma_f32_16x16x32_bf16 v[48:51], v[36:39], v[72:75], v[48:51]
    s_waitcnt lgkmcnt(4)
    v_mfma_f32_16x16x32_bf16 v[52:55], v[36:39], v[76:79], v[52:55]
    s_waitcnt lgkmcnt(3)
    v_mfma_f32_16x16x32_bf16 v[48:51], v[40:43], v[80:83], v[48:51]
    s_waitcnt lgkmcnt(2)
    v_mfma_f32_16x16x32_bf16 v[52:55], v[40:43], v[84:87], v[52:55]
    s_waitcnt lgkmcnt(1)
    v_mfma_f32_16x16x32_bf16 v[48:51], v[44:47], v[88:91], v[48:51]
    s_waitcnt lgkmcnt(0)
    v_mfma_f32_16x16x32_bf16 v[52:55], v[44:47], v[92:95], v[52:55]
    s_branch L_pend90
L_drain94:
    s_cmp_eq_u32 s75, -1
    s_cbranch_scc1 L_pend90
    s_waitcnt vmcnt(24)
    s_cmp_ge_i32 s71, 2
    s_cbranch_scc1 L_wy117
    s_waitcnt vmcnt(16)
    s_cmp_ge_i32 s71, 1
    s_cbranch_scc1 L_wy117
    s_waitcnt vmcnt(8)
L_wy117:
    v_lshlrev_b32 v56, 16, v110
    v_and_b32 v57, 0xffff0000, v110
    v_lshlrev_b32 v58, 16, v111
    v_and_b32 v59, 0xffff0000, v111
    v_fma_f32 v56, v56, s65, v30
    v_fma_f32 v57, v57, s65, v30
    v_fma_f32 v58, v58, s65, v30
    v_fma_f32 v59, v59, s65, v30
    v_exp_f32 v56, v56
    v_exp_f32 v57, v57
    v_exp_f32 v58, v58
    v_exp_f32 v59, v59
    s_nop 0
    v_cvt_pk_bf16_f32 v56, v56, v56
    v_cvt_pk_bf16_f32 v57, v57, v57
    v_cvt_pk_bf16_f32 v58, v58, v58
    v_cvt_pk_bf16_f32 v59, v59, v59
    v_and_b32 v32, v56, v24
    v_and_b32 v33, v56, v25
    v_and_b32 v34, v56, v26
    v_and_b32 v35, v56, v27
    v_and_b32 v36, v57, v24
    v_and_b32 v37, v57, v25
    v_and_b32 v38, v57, v26
    v_and_b32 v39, v57, v27
    v_and_b32 v40, v58, v24
    v_and_b32 v41, v58, v25
    v_and_b32 v42, v58, v26
    v_and_b32 v43, v58, v27
    v_and_b32 v44, v59, v24
    v_and_b32 v45, v59, v25
    v_and_b32 v46, v59, v26
    v_and_b32 v47, v59, v27
    s_waitcnt vmcnt(16)
    s_cmp_ge_i32 s71, 2
    s_cbranch_scc1 L_wy118
    s_waitcnt vmcnt(8)
    s_cmp_ge_i32 s71, 1
    s_cbranch_scc1 L_wy118
    s_waitcnt vmcnt(0)
L_wy118:
    ds_read_b128 v[64:67], v22 offset:24576
    ds_read_b128 v[68:71], v22 offset:24832
    ds_read_b128 v[72:75], v22 offset:26624
    ds_read_b128 v[76:79], v22 offset:26880
    ds_read_b128 v[80:83], v22 offset:28672
    ds_read_b128 v[84:87], v22 offset:28928
    ds_read_b128 v[88:91], v22 offset:30720
    ds_read_b128 v[92:95], v22 offset:30976
    s_waitcnt lgkmcnt(7)
    v_mfma_f32_16x16x32_bf16 v[48:51], v[32:35], v[64:67], v[48:51]
    s_waitcnt lgkmcnt(6)
    v_mfma_f32_16x16x32_bf16 v[52:55], v[32:35], v[68:71], v[52:55]
    s_waitcnt lgkmcnt(5)
    v_mfma_f32_16x16x32_bf16 v[48:51], v[36:39], v[72:75], v[48:51]
    s_waitcnt lgkmcnt(4)
    v_mfma_f32_16x16x32_bf16 v[52:55], v[36:39], v[76:79], v[52:55]
    s_waitcnt lgkmcnt(3)
    v_mfma_f32_16x16x32_bf16 v[48:51], v[40:43], v[80:83], v[48:51]
    s_waitcnt lgkmcnt(2)
    v_mfma_f32_16x16x32_bf16 v[52:55], v[40:43], v[84:87], v[52:55]
    s_waitcnt lgkmcnt(1)
    v_mfma_f32_16x16x32_bf16 v[48:51], v[44:47], v[88:91], v[48:51]
    s_waitcnt lgkmcnt(0)
    v_mfma_f32_16x16x32_bf16 v[52:55], v[44:47], v[92:95], v[52:55]
    s_sub_u32 s71, s71, 1
    s_cmp_eq_u32 s72, -1
    s_cbranch_scc1 L_pend90
    s_waitcnt vmcnt(24)
    s_cmp_ge_i32 s71, 2
    s_cbranch_scc1 L_wy119
    s_waitcnt vmcnt(16)
    s_cmp_ge_i32 s71, 1
    s_cbranch_scc1 L_wy119
    s_waitcnt vmcnt(8)
L_wy119:
    v_lshlrev_b32 v56, 16, v104
    v_and_b32 v57, 0xffff0000, v104
    v_lshlrev_b32 v58, 16, v105
    v_and_b32 v59, 0xffff0000, v105
    v_fma_f32 v56, v56, s65, v30
    v_fma_f32 v57, v57, s65, v30
    v_fma_f32 v58, v58, s65, v30
    v_fma_f32 v59, v59, s65, v30
    v_exp_f32 v56, v56
    v_exp_f32 v57, v57
    v_exp_f32 v58, v58
    v_exp_f32 v59, v59
    s_nop 0
    v_cvt_pk_bf16_f32 v56, v56, v56
    v_cvt_pk_bf16_f32 v57, v57, v57
    v_cvt_pk_bf16_f32 v58, v58, v58
    v_cvt_pk_bf16_f32 v59, v59, v59
    v_and_b32 v32, v56, v24
    v_and_b32 v33, v56, v25
    v_and_b32 v34, v56, v26
    v_and_b32 v35, v56, v27
    v_and_b32 v36, v57, v24
    v_and_b32 v37, v57, v25
    v_and_b32 v38, v57, v26
    v_and_b32 v39, v57, v27
    v_and_b32 v40, v58, v24
    v_and_b32 v41, v58, v25
    v_and_b32 v42, v58, v26
    v_and_b32 v43, v58, v27
    v_and_b32 v44, v59, v24
    v_and_b32 v45, v59, v25
    v_and_b32 v46, v59, v26
    v_and_b32 v47, v59, v27
    s_waitcnt vmcnt(16)
    s_cmp_ge_i32 s71, 2
    s_cbranch_scc1 L_wy120
    s_waitcnt vmcnt(8)
    s_cmp_ge_i32 s71, 1
    s_cbranch_scc1 L_wy120
    s_waitcnt vmcnt(0)
L_wy120:
    ds_read_b128 v[64:67], v22 offset:0
    ds_read_b128 v[68:71], v22 offset:256
    ds_read_b128 v[72:75], v22 offset:2048
    ds_read_b128 v[76:79], v22 offset:2304
    ds_read_b128 v[80:83], v22 offset:4096
    ds_read_b128 v[84:87], v22 offset:4352
    ds_read_b128 v[88:91], v22 offset:6144
    ds_read_b128 v[92:95], v22 offset:6400
    s_waitcnt lgkmcnt(7)
    v_mfma_f32_16x16x32_bf16 v[48:51], v[32:35], v[64:67], v[48:51]
    s_waitcnt lgkmcnt(6)
    v_mfma_f32_16x16x32_bf16 v[52:55], v[32:35], v[68:71], v[52:55]
    s_waitcnt lgkmcnt(5)
    v_mfma_f32_16x16x32_bf16 v[48:51], v[36:39], v[72:75], v[48:51]
    s_waitcnt lgkmcnt(4)
    v_mfma_f32_16x16x32_bf16 v[52:55], v[36:39], v[76:79], v[52:55]
    s_waitcnt lgkmcnt(3)
    v_mfma_f32_16x16x32_bf16 v[48:51], v[40:43], v[80:83], v[48:51]
    s_waitcnt lgkmcnt(2)
    v_mfma_f32_16x16x32_bf16 v[52:55], v[40:43], v[84:87], v[52:55]
    s_waitcnt lgkmcnt(1)
    v_mfma_f32_16x16x32_bf16 v[48:51], v[44:47], v[88:91], v[48:51]
    s_waitcnt lgkmcnt(0)
    v_mfma_f32_16x16x32_bf16 v[52:55], v[44:47], v[92:95], v[52:55]
    s_sub_u32 s71, s71, 1
    s_cmp_eq_u32 s73, -1
    s_cbranch_scc1 L_pend90
    s_waitcnt vmcnt(24)
    s_cmp_ge_i32 s71, 2
    s_cbranch_scc1 L_wy121
    s_waitcnt vmcnt(16)
    s_cmp_ge_i32 s71, 1
    s_cbranch_scc1 L_wy121
    s_waitcnt vmcnt(8)
L_wy121:
    v_lshlrev_b32 v56, 16, v106
    v_and_b32 v57, 0xffff0000, v106
    v_lshlrev_b32 v58, 16, v107
    v_and_b32 v59, 0xffff0000, v107
    v_fma_f32 v56, v56, s65, v30
    v_fma_f32 v57, v57, s65, v30
    v_fma_f32 v58, v58, s65, v30
    v_fma_f32 v59, v59, s65, v30
    v_exp_f32 v56, v56
    v_exp_f32 v57, v57
    v_exp_f32 v58, v58
    v_exp_f32 v59, v59
    s_nop 0
    v_cvt_pk_bf16_f32 v56, v56, v56
    v_cvt_pk_bf16_f32 v57, v57, v57
    v_cvt_pk_bf16_f32 v58, v58, v58
    v_cvt_pk_bf16_f32 v59, v59, v59
    v_and_b32 v32, v56, v24
    v_and_b32 v33, v56, v25
    v_and_b32 v34, v56, v26
    v_and_b32 v35, v56, v27
    v_and_b32 v36, v57, v24
    v_and_b32 v37, v57, v25
    v_and_b32 v38, v57, v26
    v_and_b32 v39, v57, v27
    v_and_b32 v40, v58, v24
    v_and_b32 v41, v58, v25
    v_and_b32 v42, v58, v26
    v_and_b32 v43, v58, v27
    v_and_b32 v44, v59, v24
    v_and_b32 v45, v59, v25
    v_and_b32 v46, v59, v26
    v_and_b32 v47, v59, v27
    s_waitcnt vmcnt(16)
    s_cmp_ge_i32 s71, 2
    s_cbranch_scc1 L_wy122
    s_waitcnt vmcnt(8)
    s_cmp_ge_i32 s71, 1
    s_cbranch_scc1 L_wy122
    s_waitcnt vmcnt(0)
L_wy122:
    ds_read_b128 v[64:67], v22 offset:8192
    ds_read_b128 v[68:71], v22 offset:8448
    ds_read_b128 v[72:75], v22 offset:10240
    ds_read_b128 v[76:79], v22 offset:10496
    ds_read_b128 v[80:83], v22 offset:12288
    ds_read_b128 v[84:87], v22 offset:12544
    ds_read_b128 v[88:91], v22 offset:14336
    ds_read_b128 v[92:95], v22 offset:14592
    s_waitcnt lgkmcnt(7)
    v_mfma_f32_16x16x32_bf16 v[48:51], v[32:35], v[64:67], v[48:51]
    s_waitcnt lgkmcnt(6)
    v_mfma_f32_16x16x32_bf16 v[52:55], v[32:35], v[68:71], v[52:55]
    s_waitcnt lgkmcnt(5)
    v_mfma_f32_16x16x32_bf16 v[48:51], v[36:39], v[72:75], v[48:51]
    s_waitcnt lgkmcnt(4)
    v_mfma_f32_16x16x32_bf16 v[52:55], v[36:39], v[76:79], v[52:55]
    s_waitcnt lgkmcnt(3)
    v_mfma_f32_16x16x32_bf16 v[48:51], v[40:43], v[80:83], v[48:51]
    s_waitcnt lgkmcnt(2)
    v_mfma_f32_16x16x32_bf16 v[52:55], v[40:43], v[84:87], v[52:55]
    s_waitcnt lgkmcnt(1)
    v_mfma_f32_16x16x32_bf16 v[48:51], v[44:47], v[88:91], v[48:51]
    s_waitcnt lgkmcnt(0)
    v_mfma_f32_16x16x32_bf16 v[52:55], v[44:47], v[92:95], v[52:55]
L_pend90:
    s_lshl_b32 s63, s2, 11
    s_add_u32 s63, s63, 65536
    s_nop 6
    ds_write_b128 v6, v[48:51]
    ds_write_b128 v6, v[52:55] offset:512
    s_waitcnt lgkmcnt(0)
    s_barrier
    s_mov_b32 exec_hi, 0
    ds_read_b128 v[64:67], v4
    ds_read_b128 v[68:71], v4 offset:32768
    ds_read_b128 v[72:75], v5
    ds_read_b128 v[76:79], v5 offset:32768
    ds_read_b32 v80, v3
    s_waitcnt lgkmcnt(3)
    v_add_f32 v64, v64, v68
    v_add_f32 v65, v65, v69
    v_add_f32 v66, v66, v70
    v_add_f32 v67, v67, v71
    s_waitcnt lgkmcnt(1)
    v_add_f32 v72, v72, v76
    v_add_f32 v73, v73, v77
    v_add_f32 v74, v74, v78
    v_add_f32 v75, v75, v79
    v_add_f32 v64, v64, v72
    v_add_f32 v65, v65, v73
    v_add_f32 v66, v66, v74
    v_add_f32 v67, v67, v75
    s_waitcnt lgkmcnt(0)
    v_mul_f32 v64, v64, v80
    v_mul_f32 v65, v65, v80
    v_mul_f32 v66, v66, v80
    v_mul_f32 v67, v67, v80
    v_min_u32 v64, -2, v64
    v_min_u32 v65, -2, v65
    v_min_u32 v66, -2, v66
    v_min_u32 v67, -2, v67
    buffer_store_dwordx4 v[64:67], v4, s[56:59], s63 offen sc1
    s_endpgm
L_aux:
    s_setprio 3
    v_lshrrev_b32 v7, 1, v2
    v_and_b32 v20, 1, v2
    v_lshlrev_b32 v20, 4, v20
    v_lshl_add_u32 v4, v7, 13, v20
    v_lshlrev_b32 v3, 4, v2
    s_and_b32 s4, s2, 7
    s_lshr_b32 s5, s2, 5
    s_add_u32 s5, s5, s4
    s_and_b32 s5, s5, 7
    s_lshl_b32 s5, s5, 2
    s_lshl_b32 s62, s4, 5
    s_add_u32 s62, s62, s5
    s_bfe_u32 s5, s2, 0x20003
    s_add_u32 s62, s62, s5
    s_lshl_b32 s63, s62, 5
    s_waitcnt lgkmcnt(0)
    s_load_dword s60, s[40:41], 0
    s_mov_b32 s52, s16
    s_mov_b32 s53, s17
    s_mov_b32 s54, 0x380
    s_mov_b32 s55, 0x20000
    buffer_load_dwordx4 v[8:11], v3, s[52:55], 0 offen
    s_mov_b32 s44, s22
    s_mov_b32 s45, s23
    s_mov_b32 s46, 0x380000
    s_mov_b32 s47, 0x20000
    s_waitcnt vmcnt(6)
    s_mov_b32 m0, 139264
    s_nop 0
    buffer_load_dwordx4 v4, s[44:47], s63 offen nt lds
    s_waitcnt vmcnt(6)
    s_mov_b32 m0, 140288
    s_add_u32 s63, s63, 262144
    buffer_load_dwordx4 v4, s[44:47], s63 offen nt lds
    s_waitcnt vmcnt(6)
    s_mov_b32 m0, 141312
    s_add_u32 s63, s63, 262144
    buffer_load_dwordx4 v4, s[44:47], s63 offen nt lds
    s_waitcnt vmcnt(6)
    s_mov_b32 m0, 142336
    s_add_u32 s63, s63, 262144
    buffer_load_dwordx4 v4, s[44:47], s63 offen nt lds
    s_waitcnt vmcnt(6)
    s_mov_b32 m0, 143360
    s_add_u32 s63, s63, 262144
    buffer_load_dwordx4 v4, s[44:47], s63 offen nt lds
    s_waitcnt vmcnt(6)
    s_mov_b32 m0, 144384
    s_add_u32 s63, s63, 262144
    buffer_load_dwordx4 v4, s[44:47], s63 offen nt lds
    s_waitcnt vmcnt(6)
    s_mov_b32 m0, 145408
    s_add_u32 s63, s63, 262144
    buffer_load_dwordx4 v4, s[44:47], s63 offen nt lds
    s_waitcnt vmcnt(6)
    s_mov_b32 m0, 146432
    s_add_u32 s63, s63, 262144
    buffer_load_dwordx4 v4, s[44:47], s63 offen nt lds
    s_waitcnt vmcnt(6)
    s_mov_b32 m0, 147456
    s_add_u32 s63, s63, 262144
    buffer_load_dwordx4 v4, s[44:47], s63 offen nt lds
    s_waitcnt vmcnt(6)
    s_mov_b32 m0, 148480
    s_add_u32 s63, s63, 262144
    buffer_load_dwordx4 v4, s[44:47], s63 offen nt lds
    s_waitcnt vmcnt(6)
    s_mov_b32 m0, 149504
    s_add_u32 s63, s63, 262144
    buffer_load_dwordx4 v4, s[44:47], s63 offen nt lds
    s_waitcnt vmcnt(6)
    s_mov_b32 m0, 150528
    s_add_u32 s63, s63, 262144
    buffer_load_dwordx4 v4, s[44:47], s63 offen nt lds
    s_waitcnt vmcnt(6)
    s_mov_b32 m0, 151552
    s_add_u32 s63, s63, 262144
    buffer_load_dwordx4 v4, s[44:47], s63 offen nt lds
    s_waitcnt vmcnt(6)
    s_mov_b32 m0, 152576
    s_add_u32 s63, s63, 262144
    buffer_load_dwordx4 v4, s[44:47], s63 offen nt lds
    s_mov_b32 s56, s40
    s_mov_b32 s57, s41
    s_mov_b32 s58, 0x40000000
    s_mov_b32 s59, 0x20000
    v_lshrrev_b32 v20, 4, v2
    v_bfe_u32 v21, v2, 2, 2
    v_lshl_add_u32 v21, v20, 3, v21
    v_and_b32 v22, 3, v2
    v_lshlrev_b32 v22, 3, v22
    v_add_u32 v22, 139264, v22
    v_lshl_add_u32 v5, v21, 5, v22
    v_lshl_add_u32 v222, v21, 7, v22
    v_lshlrev_b32 v20, 4, v20
    v_add_u32 v6, 155648, v20
    v_cmp_gt_u32 s[74:75], 56, v2
    s_waitcnt vmcnt(14)
    v_lshlrev_b32 v12, 16, v8
    v_and_b32 v13, 0xffff0000, v8
    v_lshlrev_b32 v14, 16, v9
    v_and_b32 v15, 0xffff0000, v9
    v_lshlrev_b32 v16, 16, v10
    v_and_b32 v17, 0xffff0000, v10
    v_lshlrev_b32 v18, 16, v11
    v_and_b32 v19, 0xffff0000, v11
    v_add_f32 v20, v12, v13
    v_add_f32 v21, v14, v15
    v_add_f32 v22, v16, v17
    v_add_f32 v23, v18, v19
    v_add_f32 v20, v20, v21
    v_add_f32 v22, v22, v23
    v_add_f32 v20, v20, v22
    s_nop 1
    v_add_f32_dpp v20, v20, v20 row_ror:1 row_mask:0xf bank_mask:0xf
    s_nop 1
    v_add_f32_dpp v20, v20, v20 row_ror:2 row_mask:0xf bank_mask:0xf
    s_nop 1
    v_add_f32_dpp v20, v20, v20 row_ror:4 row_mask:0xf bank_mask:0xf
    s_nop 1
    v_add_f32_dpp v20, v20, v20 row_ror:8 row_mask:0xf bank_mask:0xf
    v_mov_b32 v21, v20
    s_nop 1
    v_permlane16_swap_b32 v20, v21
    v_add_f32 v20, v20, v21
    v_mov_b32 v21, v20
    s_nop 1
    v_permlane32_swap_b32 v20, v21
    v_add_f32 v20, v20, v21
    v_mul_f32 v20, 0x3b124925, v20
    v_sub_f32 v22, v12, v20
    v_mul_f32 v21, v22, v22
    v_sub_f32 v22, v13, v20
    v_fmac_f32 v21, v22, v22
    v_sub_f32 v22, v14, v20
    v_fmac_f32 v21, v22, v22
    v_sub_f32 v22, v15, v20
    v_fmac_f32 v21, v22, v22
    v_sub_f32 v22, v16, v20
    v_fmac_f32 v21, v22, v22
    v_sub_f32 v22, v17, v20
    v_fmac_f32 v21, v22, v22
    v_sub_f32 v22, v18, v20
    v_fmac_f32 v21, v22, v22
    v_sub_f32 v22, v19, v20
    v_fmac_f32 v21, v22, v22
    v_cndmask_b32 v21, 0, v21, s[74:75]
    s_nop 1
    v_add_f32_dpp v21, v21, v21 row_ror:1 row_mask:0xf bank_mask:0xf
    s_nop 1
    v_add_f32_dpp v21, v21, v21 row_ror:2 row_mask:0xf bank_mask:0xf
    s_nop 1
    v_add_f32_dpp v21, v21, v21 row_ror:4 row_mask:0xf bank_mask:0xf
    s_nop 1
    v_add_f32_dpp v21, v21, v21 row_ror:8 row_mask:0xf bank_mask:0xf
    v_mov_b32 v22, v21
    s_nop 1
    v_permlane16_swap_b32 v21, v22
    v_add_f32 v21, v21, v22
    v_mov_b32 v22, v21
    s_nop 1
    v_permlane32_swap_b32 v21, v22
    v_add_f32 v21, v21, v22
    v_mul_f32 v21, 0x3b124925, v21
    v_cvt_pk_bf16_f32 v20, v20, v20
    v_and_b32 v20, 0xffff0000, v20
    v_cvt_pk_bf16_f32 v21, v21, v21
    v_and_b32 v21, 0xffff0000, v21
    v_add_f32 v21, 0x3727c5ac, v21
    v_cvt_pk_bf16_f32 v21, v21, v21
    v_and_b32 v21, 0xffff0000, v21
    v_sqrt_f32 v21, v21
    s_nop 0
    v_cvt_pk_bf16_f32 v21, v21, v21
    v_and_b32 v21, 0xffff0000, v21
    v_rcp_f32 v22, v21
    v_sub_f32 v12, v12, v20
    v_sub_f32 v13, v13, v20
    v_sub_f32 v14, v14, v20
    v_sub_f32 v15, v15, v20
    v_sub_f32 v16, v16, v20
    v_sub_f32 v17, v17, v20
    v_sub_f32 v18, v18, v20
    v_sub_f32 v19, v19, v20
    v_cvt_pk_bf16_f32 v8, v12, v13
    v_cvt_pk_bf16_f32 v9, v14, v15
    v_cvt_pk_bf16_f32 v10, v16, v17
    v_cvt_pk_bf16_f32 v11, v18, v19
    v_lshlrev_b32 v12, 16, v8
    v_and_b32 v13, 0xffff0000, v8
    v_lshlrev_b32 v14, 16, v9
    v_and_b32 v15, 0xffff0000, v9
    v_lshlrev_b32 v16, 16, v10
    v_and_b32 v17, 0xffff0000, v10
    v_lshlrev_b32 v18, 16, v11
    v_and_b32 v19, 0xffff0000, v11
    v_mul_f32 v23, v12, v22
    v_fma_f32 v24, -v23, v21, v12
    v_fma_f32 v12, v24, v22, v23
    v_mul_f32 v23, v13, v22
    v_fma_f32 v24, -v23, v21, v13
    v_fma_f32 v13, v24, v22, v23
    v_mul_f32 v23, v14, v22
    v_fma_f32 v24, -v23, v21, v14
    v_fma_f32 v14, v24, v22, v23
    v_mul_f32 v23, v15, v22
    v_fma_f32 v24, -v23, v21, v15
    v_fma_f32 v15, v24, v22, v23
    v_mul_f32 v23, v16, v22
    v_fma_f32 v24, -v23, v21, v16
    v_fma_f32 v16, v24, v22, v23
    v_mul_f32 v23, v17, v22
    v_fma_f32 v24, -v23, v21, v17
    v_fma_f32 v17, v24, v22, v23
    v_mul_f32 v23, v18, v22
    v_fma_f32 v24, -v23, v21, v18
    v_fma_f32 v18, v24, v22, v23
    v_mul_f32 v23, v19, v22
    v_fma_f32 v24, -v23, v21, v19
    v_fma_f32 v19, v24, v22, v23
    v_cvt_pk_bf16_f32 v8, v12, v13
    v_cvt_pk_bf16_f32 v9, v14, v15
    v_cvt_pk_bf16_f32 v10, v16, v17
    v_cvt_pk_bf16_f32 v11, v18, v19
    v_add_u32 v20, 155648, v3
    ds_write_b128 v20, v[8:11]
    s_waitcnt lgkmcnt(0)
    ds_read_b128 v[32:35], v6 offset:0
    ds_read_b128 v[36:39], v6 offset:64
    ds_read_b128 v[40:43], v6 offset:128
    ds_read_b128 v[44:47], v6 offset:192
    ds_read_b128 v[48:51], v6 offset:256
    ds_read_b128 v[52:55], v6 offset:320
    ds_read_b128 v[56:59], v6 offset:384
    ds_read_b128 v[60:63], v6 offset:448
    ds_read_b128 v[64:67], v6 offset:512
    ds_read_b128 v[68:71], v6 offset:576
    ds_read_b128 v[72:75], v6 offset:640
    ds_read_b128 v[76:79], v6 offset:704
    ds_read_b128 v[80:83], v6 offset:768
    ds_read_b128 v[84:87], v6 offset:832
    s_waitcnt vmcnt(0)
    ds_read_b64_tr_b16 v[88:89], v5 offset:0
    ds_read_b64_tr_b16 v[90:91], v5 offset:128
    ds_read_b64_tr_b16 v[92:93], v5 offset:1024
    ds_read_b64_tr_b16 v[94:95], v5 offset:1152
    ds_read_b64_tr_b16 v[96:97], v5 offset:2048
    ds_read_b64_tr_b16 v[98:99], v5 offset:2176
    ds_read_b64_tr_b16 v[100:101], v5 offset:3072
    ds_read_b64_tr_b16 v[102:103], v5 offset:3200
    ds_read_b64_tr_b16 v[104:105], v5 offset:4096
    ds_read_b64_tr_b16 v[106:107], v5 offset:4224
    ds_read_b64_tr_b16 v[108:109], v5 offset:5120
    ds_read_b64_tr_b16 v[110:111], v5 offset:5248
    ds_read_b64_tr_b16 v[112:113], v5 offset:6144
    ds_read_b64_tr_b16 v[114:115], v5 offset:6272
    ds_read_b64_tr_b16 v[116:117], v5 offset:7168
    ds_read_b64_tr_b16 v[118:119], v5 offset:7296
    ds_read_b64_tr_b16 v[120:121], v5 offset:8192
    ds_read_b64_tr_b16 v[122:123], v5 offset:8320
    ds_read_b64_tr_b16 v[124:125], v5 offset:9216
    ds_read_b64_tr_b16 v[126:127], v5 offset:9344
    ds_read_b64_tr_b16 v[128:129], v5 offset:10240
    ds_read_b64_tr_b16 v[130:131], v5 offset:10368
    ds_read_b64_tr_b16 v[132:133], v5 offset:11264
    ds_read_b64_tr_b16 v[134:135], v5 offset:11392
    ds_read_b64_tr_b16 v[136:137], v5 offset:12288
    ds_read_b64_tr_b16 v[138:139], v5 offset:12416
    ds_read_b64_tr_b16 v[140:141], v5 offset:13312
    ds_read_b64_tr_b16 v[142:143], v5 offset:13440
    s_waitcnt lgkmcnt(0)
    v_mfma_f32_16x16x32_bf16 v[20:23], v[32:35], v[88:91], 0
    v_mfma_f32_16x16x32_bf16 v[20:23], v[36:39], v[92:95], v[20:23]
    v_mfma_f32_16x16x32_bf16 v[20:23], v[40:43], v[96:99], v[20:23]
    v_mfma_f32_16x16x32_bf16 v[20:23], v[44:47], v[100:103], v[20:23]
    v_mfma_f32_16x16x32_bf16 v[20:23], v[48:51], v[104:107], v[20:23]
    v_mfma_f32_16x16x32_bf16 v[20:23], v[52:55], v[108:111], v[20:23]
    v_mfma_f32_16x16x32_bf16 v[20:23], v[56:59], v[112:115], v[20:23]
    v_mfma_f32_16x16x32_bf16 v[20:23], v[60:63], v[116:119], v[20:23]
    v_mfma_f32_16x16x32_bf16 v[20:23], v[64:67], v[120:123], v[20:23]
    v_mfma_f32_16x16x32_bf16 v[20:23], v[68:71], v[124:127], v[20:23]
    v_mfma_f32_16x16x32_bf16 v[20:23], v[72:75], v[128:131], v[20:23]
    v_mfma_f32_16x16x32_bf16 v[20:23], v[76:79], v[132:135], v[20:23]
    v_mfma_f32_16x16x32_bf16 v[20:23], v[80:83], v[136:139], v[20:23]
    v_mfma_f32_16x16x32_bf16 v[20:23], v[84:87], v[140:143], v[20:23]
    s_mul_i32 s61, s60, 0x9E3779B1
    s_add_u32 s61, s61, 0x7F4A7C15
    s_add_u32 s72, s60, 1
    s_lshr_b32 s4, s60, 8
    s_mul_i32 s4, s4, 0x9E3779B1
    v_mov_b32 v220, 0xff
    s_mov_b32 s71, 0xffffff00
    s_lshr_b32 s4, s4, 8
    s_add_u32 s73, s72, s4
    s_lshr_b32 s4, s4, 8
    s_add_u32 s76, s72, s4
    s_lshr_b32 s4, s4, 8
    s_add_u32 s77, s72, s4
    s_lshl_b32 s63, s62, 6
    s_add_u32 s63, s63, 4096
    v_lshlrev_b32 v26, 3, v7
    v_mov_b32 v25, s61
    v_mov_b32_dpp v21, v20 quad_perm:[1,1,3,3] row_mask:0xf bank_mask:0xf
    v_cvt_pk_bf16_f32 v24, v20, v21
    s_mov_b64 exec, 0x5555
    buffer_store_dwordx2 v[24:25], v26, s[56:59], s63 offen sc1
    s_mov_b64 exec, -1
    s_lshr_b32 s63, s2, 5
    s_lshl_b32 s63, s63, 11
    s_add_u32 s63, s63, 4096
    s_sleep 50
    s_mov_b64 s[4:5], -1
    s_mov_b64 s[6:7], -1
    s_mov_b32 s64, 0
    s_mov_b32 s14, 999
L_poll124:
    s_mov_b64 exec, s[4:5]
    s_cbranch_execz L_sk127
    buffer_load_dwordx4 v[12:15], v3, s[56:59], s63 offen offset:0 sc1
L_sk127:
    s_mov_b64 exec, s[6:7]
    s_cbranch_execz L_sk128
    buffer_load_dwordx4 v[16:19], v3, s[56:59], s63 offen offset:1024 sc1
L_sk128:
    s_mov_b64 exec, -1
    s_add_u32 s64, s64, 1
L_pj126:
    s_waitcnt vmcnt(0)
    v_xor_b32 v20, s61, v13
    v_xor_b32 v24, s61, v15
    v_or_b32 v20, v20, v24
    v_xor_b32 v21, s61, v17
    v_xor_b32 v25, s61, v19
    v_or_b32 v21, v21, v25
    v_cmp_ne_u32 vcc, 0, v20
    s_and_b64 s[4:5], s[4:5], vcc
    v_cmp_ne_u32 vcc, 0, v21
    s_and_b64 s[6:7], s[6:7], vcc
    s_or_b64 s[12:13], s[4:5], s[6:7]
    s_cbranch_scc0 L_polld125
    s_sleep 16
    s_cmp_lt_u32 s64, 262144
    s_cbranch_scc1 L_poll124
L_polld125:
    v_mov_b32 v20, 157792
    v_mov_b32 v21, 0
    ds_write2_b32 v20, v21, v21 offset0:0 offset1:4
    v_lshlrev_b32 v20, 3, v2
    v_add_u32 v20, 156672, v20
    ds_write2_b32 v20, v12, v14 offset0:0 offset1:1
    ds_write2_b32 v20, v16, v18 offset0:128 offset1:129
    s_waitcnt lgkmcnt(0)
    s_barrier
    s_setprio 0
    s_and_b32 s4, s2, 31
    s_cbranch_scc1 L_nz129
    s_lshr_b32 s4, s2, 5
    s_mul_i32 s4, s4, 17408
    s_add_u32 s4, s4, 2621440
    v_mul_u32_u24 v20, 4352, v2
    v_mov_b32 v21, 0
    s_mov_b64 exec, 15
    buffer_store_dword v21, v20, s[56:59], s4 offen sc1
    s_mov_b64 exec, -1
L_nz129:
    s_bfe_u32 s67, s2, 0x10003
    s_lshr_b32 s66, s2, 4
    s_lshl_b32 s66, s66, 3
    s_and_b32 s63, s2, 7
    s_add_u32 s66, s66, s63
    v_and_b32 v20, 15, v2
    v_and_b32 v21, 1, v20
    v_lshlrev_b32 v21, 4, v21
    v_mov_b32 v22, 0xffff
    v_lshlrev_b32 v22, v21, v22
    v_bfe_u32 v21, v20, 1, 2
    v_cmp_eq_u32 vcc, 0, v21
    s_nop 1
    v_cndmask_b32 v216, 0, v22, vcc
    v_cmp_eq_u32 vcc, 1, v21
    s_nop 1
    v_cndmask_b32 v217, 0, v22, vcc
    v_cmp_eq_u32 vcc, 2, v21
    s_nop 1
    v_cndmask_b32 v218, 0, v22, vcc
    v_cmp_eq_u32 vcc, 3, v21
    s_nop 1
    v_cndmask_b32 v219, 0, v22, vcc
    v_lshrrev_b32 v21, 4, v2
    v_mul_u32_u24 v225, 896, v21
    v_lshl_add_u32 v225, v20, 4, v225
    v_mov_b32 v208, 0
    v_mov_b32 v209, 0
    v_mov_b32 v210, 0
    v_mov_b32 v211, 0
    v_mov_b32 v212, 0
    v_mov_b32 v213, 0
    v_mov_b32 v214, 0
    v_mov_b32 v215, 0
    v_lshrrev_b32 v20, 5, v2
    v_lshlrev_b32 v20, 9, v20
    v_and_b32 v21, 15, v2
    v_lshl_add_u32 v20, v21, 5, v20
    v_bfe_u32 v21, v2, 4, 1
    v_lshl_add_u32 v224, v21, 4, v20
    s_lshl_b32 s62, s67, 7
    s_add_u32 s62, s62, s66
    s_lshl_b32 s62, s62, 10
    s_add_u32 s62, s62, 1048576
    v_mov_b32 v12, -1
    v_mov_b32 v13, -1
    v_mov_b32 v14, -1
    v_mov_b32 v15, -1
    s_lshl_b32 s4, s2, 11
    s_add_u32 s4, s4, 65536
    buffer_store_dwordx4 v[12:15], v3, s[56:59], s4 offen sc1
    s_waitcnt vmcnt(1)
    buffer_store_dwordx4 v[12:15], v3, s[56:59], s4 offen offset:1024 sc1
    s_waitcnt vmcnt(1)
    s_nop 1
    s_and_b32 s4, s2, 7
    s_lshr_b32 s5, s2, 5
    s_bfe_u32 s6, s2, 0x20003
    s_and_b32 s7, s5, 3
    s_cmp_gt_u32 s6, s7
    s_subb_u32 s8, s6, 0
    s_lshl_b32 s8, s8, 3
    s_add_u32 s8, s8, s4
    s_cmp_eq_u32 s6, s7
    s_cselect_b32 s8, 24, s8
    s_cselect_b32 s9, s4, s5
    s_cmp_lg_u32 s9, s5
    s_cbranch_scc1 L_nomlp130
    s_mul_i32 s9, s5, 25
    s_add_u32 s8, s8, s9
    s_cmp_ge_u32 s8, 196
    s_cbranch_scc1 L_nomlp130
    s_mul_i32 s9, s8, 2341
    s_lshr_b32 s9, s9, 16
    s_mul_i32 s10, s9, 28
    s_sub_u32 s8, s8, s10
    v_lshrrev_b32 v20, 3, v2
    v_mul_u32_u24 v4, 3584, v20
    v_and_b32 v20, 7, v2
    v_lshl_add_u32 v4, v20, 4, v4
    s_mov_b32 s44, s28
    s_mov_b32 s45, s29
    s_mov_b32 s46, 0x188000
    s_mov_b32 s47, 0x20000
    s_mul_i32 s63, s9, 229376
    s_lshl_b32 s10, s8, 7
    s_add_u32 s63, s63, s10
    s_waitcnt vmcnt(6)
    s_mov_b32 m0, 139264
    s_nop 0
    buffer_load_dwordx4 v4, s[44:47], s63 offen nt lds
    s_add_u32 s63, s63, 28672
    s_waitcnt vmcnt(6)
    s_mov_b32 m0, 140288
    s_nop 0
    buffer_load_dwordx4 v4, s[44:47], s63 offen nt lds
    s_add_u32 s63, s63, 28672
    s_waitcnt vmcnt(6)
    s_mov_b32 m0, 141312
    s_nop 0
    buffer_load_dwordx4 v4, s[44:47], s63 offen nt lds
    s_add_u32 s63, s63, 28672
    s_waitcnt vmcnt(6)
    s_mov_b32 m0, 142336
    s_nop 0
    buffer_load_dwordx4 v4, s[44:47], s63 offen nt lds
    s_add_u32 s63, s63, 28672
    s_waitcnt vmcnt(6)
    s_mov_b32 m0, 143360
    s_nop 0
    buffer_load_dwordx4 v4, s[44:47], s63 offen nt lds
    s_add_u32 s63, s63, 28672
    s_waitcnt vmcnt(6)
    s_mov_b32 m0, 144384
    s_nop 0
    buffer_load_dwordx4 v4, s[44:47], s63 offen nt lds
    s_add_u32 s63, s63, 28672
    s_waitcnt vmcnt(6)
    s_mov_b32 m0, 145408
    s_nop 0
    buffer_load_dwordx4 v4, s[44:47], s63 offen nt lds
    s_add_u32 s63, s63, 28672
    s_waitcnt vmcnt(6)
    s_mov_b32 m0, 146432
    s_nop 0
    buffer_load_dwordx4 v4, s[44:47], s63 offen nt lds
    s_add_u32 s63, s63, 28672
    s_lshl_b32 s10, s9, 7
    v_add_u32 v20, s10, v6
    ds_read_b128 v[32:35], v20
    ds_read_b128 v[36:39], v20 offset:64
    s_waitcnt vmcnt(0)
    ds_read_b64_tr_b16 v[144:145], v222 offset:0
    ds_read_b64_tr_b16 v[146:147], v222 offset:512
    ds_read_b64_tr_b16 v[148:149], v222 offset:32
    ds_read_b64_tr_b16 v[150:151], v222 offset:544
    ds_read_b64_tr_b16 v[152:153], v222 offset:64
    ds_read_b64_tr_b16 v[154:155], v222 offset:576
    ds_read_b64_tr_b16 v[156:157], v222 offset:96
    ds_read_b64_tr_b16 v[158:159], v222 offset:608
    ds_read_b64_tr_b16 v[160:161], v222 offset:4096
    ds_read_b64_tr_b16 v[162:163], v222 offset:4608
    ds_read_b64_tr_b16 v[164:165], v222 offset:4128
    ds_read_b64_tr_b16 v[166:167], v222 offset:4640
    ds_read_b64_tr_b16 v[168:169], v222 offset:4160
    ds_read_b64_tr_b16 v[170:171], v222 offset:4672
    ds_read_b64_tr_b16 v[172:173], v222 offset:4192
    ds_read_b64_tr_b16 v[174:175], v222 offset:4704
    s_waitcnt lgkmcnt(0)
    v_mfma_f32_16x16x32_bf16 v[88:91], v[32:35], v[144:147], 0
    v_mfma_f32_16x16x32_bf16 v[92:95], v[32:35], v[148:151], 0
    v_mfma_f32_16x16x32_bf16 v[96:99], v[32:35], v[152:155], 0
    v_mfma_f32_16x16x32_bf16 v[100:103], v[32:35], v[156:159], 0
    v_mfma_f32_16x16x32_bf16 v[88:91], v[36:39], v[160:163], v[88:91]
    v_mfma_f32_16x16x32_bf16 v[92:95], v[36:39], v[164:167], v[92:95]
    v_mfma_f32_16x16x32_bf16 v[96:99], v[36:39], v[168:171], v[96:99]
    v_mfma_f32_16x16x32_bf16 v[100:103], v[36:39], v[172:175], v[100:103]
    s_lshl_b32 s8, s8, 11
    s_lshl_b32 s9, s9, 8
    s_add_u32 s8, s8, s9
    s_add_u32 s8, s8, 1835008
    s_nop 7
    v_add_u32 v12, 0x80, v88
    v_bfi_b32 v12, v220, s72, v12
    v_add_u32 v13, 0x80, v92
    v_bfi_b32 v13, v220, s73, v13
    v_add_u32 v14, 0x80, v96
    v_bfi_b32 v14, v220, s76, v14
    v_add_u32 v15, 0x80, v100
    v_bfi_b32 v15, v220, s77, v15
    s_mov_b64 exec, 0xffff
    buffer_store_dwordx4 v[12:15], v3, s[56:59], s8 offen sc1
    s_mov_b64 exec, -1
    s_branch L_nomlp130
L_nomlp130:
    s_barrier
    s_mov_b32 s65, 0x3db8aa3b
    s_lshr_b32 s4, s2, 5
    s_lshl_b32 s4, s4, 9
    s_add_u32 s4, s4, 32768
    s_mov_b32 exec_hi, 0
    buffer_load_dwordx4 v[88:91], v3, s[56:59], s4 offen sc1
    s_mov_b32 exec_hi, -1
    v_bfe_u32 v20, v2, 2, 2
    v_lshlrev_b32 v20, 11, v20
    v_lshrrev_b32 v21, 4, v2
    v_lshl_add_u32 v20, v21, 6, v20
    v_and_b32 v21, 3, v2
    v_lshl_add_u32 v20, v21, 4, v20
    v_add_u32 v20, 132864, v20
    ds_read_b128 v[8:11], v20
    s_lshl_b32 s4, s2, 10
    s_add_u32 s4, s4, 2097152
    s_waitcnt lgkmcnt(0)
    buffer_store_dwordx4 v[8:11], v3, s[56:59], s4 offen sc1
    v_and_b32 v20, 1, v2
    v_lshlrev_b32 v21, 4, v20
    v_add_u32 v21, 157696, v21
    v_lshlrev_b32 v22, 5, v2
    v_add_u32 v22, 131072, v22
    ds_read_b128 v[12:15], v21
    ds_read_b128 v[32:35], v22 offset:0
    ds_read_b128 v[36:39], v22 offset:16
    ds_read_b128 v[40:43], v22 offset:2048
    ds_read_b128 v[44:47], v22 offset:2064
    ds_read_b128 v[48:51], v22 offset:4096
    ds_read_b128 v[52:55], v22 offset:4112
    ds_read_b128 v[56:59], v22 offset:6144
    ds_read_b128 v[60:63], v22 offset:6160
    s_waitcnt lgkmcnt(0)
    v_max_f32 v12, v12, v13
    v_max3_f32 v12, v12, v14, v15
    v_mul_f32 v16, s65, v12
    v_sub_f32 v16, 0, v16
    v_mov_b32 v13, 0
    v_mov_b32 v17, 0
    v_lshlrev_b32 v23, 16, v32
    v_and_b32 v24, 0xffff0000, v32
    v_fma_f32 v23, v23, s65, v16
    v_fma_f32 v24, v24, s65, v16
    v_exp_f32 v23, v23
    v_exp_f32 v24, v24
    s_nop 0
    v_add_f32 v13, v13, v23
    v_add_f32 v17, v17, v24
    v_lshlrev_b32 v23, 16, v33
    v_and_b32 v24, 0xffff0000, v33
    v_fma_f32 v23, v23, s65, v16
    v_fma_f32 v24, v24, s65, v16
    v_exp_f32 v23, v23
    v_exp_f32 v24, v24
    s_nop 0
    v_add_f32 v13, v13, v23
    v_add_f32 v17, v17, v24
    v_lshlrev_b32 v23, 16, v34
    v_and_b32 v24, 0xffff0000, v34
    v_fma_f32 v23, v23, s65, v16
    v_fma_f32 v24, v24, s65, v16
    v_exp_f32 v23, v23
    v_exp_f32 v24, v24
    s_nop 0
    v_add_f32 v13, v13, v23
    v_add_f32 v17, v17, v24
    v_lshlrev_b32 v23, 16, v35
    v_and_b32 v24, 0xffff0000, v35
    v_fma_f32 v23, v23, s65, v16
    v_fma_f32 v24, v24, s65, v16
    v_exp_f32 v23, v23
    v_exp_f32 v24, v24
    s_nop 0
    v_add_f32 v13, v13, v23
    v_add_f32 v17, v17, v24
    v_lshlrev_b32 v23, 16, v36
    v_and_b32 v24, 0xffff0000, v36
    v_fma_f32 v23, v23, s65, v16
    v_fma_f32 v24, v24, s65, v16
    v_exp_f32 v23, v23
    v_exp_f32 v24, v24
    s_nop 0
    v_add_f32 v13, v13, v23
    v_add_f32 v17, v17, v24
    v_lshlrev_b32 v23, 16, v37
    v_and_b32 v24, 0xffff0000, v37
    v_fma_f32 v23, v23, s65, v16
    v_fma_f32 v24, v24, s65, v16
    v_exp_f32 v23, v23
    v_exp_f32 v24, v24
    s_nop 0
    v_add_f32 v13, v13, v23
    v_add_f32 v17, v17, v24
    v_lshlrev_b32 v23, 16, v38
    v_and_b32 v24, 0xffff0000, v38
    v_fma_f32 v23, v23, s65, v16
    v_fma_f32 v24, v24, s65, v16
    v_exp_f32 v23, v23
    v_exp_f32 v24, v24
    s_nop 0
    v_add_f32 v13, v13, v23
    v_add_f32 v17, v17, v24
    v_lshlrev_b32 v23, 16, v39
    v_and_b32 v24, 0xffff0000, v39
    v_fma_f32 v23, v23, s65, v16
    v_fma_f32 v24, v24, s65, v16
    v_exp_f32 v23, v23
    v_exp_f32 v24, v24
    s_nop 0
    v_add_f32 v13, v13, v23
    v_add_f32 v17, v17, v24
    v_lshlrev_b32 v23, 16, v40
    v_and_b32 v24, 0xffff0000, v40
    v_fma_f32 v23, v23, s65, v16
    v_fma_f32 v24, v24, s65, v16
    v_exp_f32 v23, v23
    v_exp_f32 v24, v24
    s_nop 0
    v_add_f32 v13, v13, v23
    v_add_f32 v17, v17, v24
    v_lshlrev_b32 v23, 16, v41
    v_and_b32 v24, 0xffff0000, v41
    v_fma_f32 v23, v23, s65, v16
    v_fma_f32 v24, v24, s65, v16
    v_exp_f32 v23, v23
    v_exp_f32 v24, v24
    s_nop 0
    v_add_f32 v13, v13, v23
    v_add_f32 v17, v17, v24
    v_lshlrev_b32 v23, 16, v42
    v_and_b32 v24, 0xffff0000, v42
    v_fma_f32 v23, v23, s65, v16
    v_fma_f32 v24, v24, s65, v16
    v_exp_f32 v23, v23
    v_exp_f32 v24, v24
    s_nop 0
    v_add_f32 v13, v13, v23
    v_add_f32 v17, v17, v24
    v_lshlrev_b32 v23, 16, v43
    v_and_b32 v24, 0xffff0000, v43
    v_fma_f32 v23, v23, s65, v16
    v_fma_f32 v24, v24, s65, v16
    v_exp_f32 v23, v23
    v_exp_f32 v24, v24
    s_nop 0
    v_add_f32 v13, v13, v23
    v_add_f32 v17, v17, v24
    v_lshlrev_b32 v23, 16, v44
    v_and_b32 v24, 0xffff0000, v44
    v_fma_f32 v23, v23, s65, v16
    v_fma_f32 v24, v24, s65, v16
    v_exp_f32 v23, v23
    v_exp_f32 v24, v24
    s_nop 0
    v_add_f32 v13, v13, v23
    v_add_f32 v17, v17, v24
    v_lshlrev_b32 v23, 16, v45
    v_and_b32 v24, 0xffff0000, v45
    v_fma_f32 v23, v23, s65, v16
    v_fma_f32 v24, v24, s65, v16
    v_exp_f32 v23, v23
    v_exp_f32 v24, v24
    s_nop 0
    v_add_f32 v13, v13, v23
    v_add_f32 v17, v17, v24
    v_lshlrev_b32 v23, 16, v46
    v_and_b32 v24, 0xffff0000, v46
    v_fma_f32 v23, v23, s65, v16
    v_fma_f32 v24, v24, s65, v16
    v_exp_f32 v23, v23
    v_exp_f32 v24, v24
    s_nop 0
    v_add_f32 v13, v13, v23
    v_add_f32 v17, v17, v24
    v_lshlrev_b32 v23, 16, v47
    v_and_b32 v24, 0xffff0000, v47
    v_fma_f32 v23, v23, s65, v16
    v_fma_f32 v24, v24, s65, v16
    v_exp_f32 v23, v23
    v_exp_f32 v24, v24
    s_nop 0
    v_add_f32 v13, v13, v23
    v_add_f32 v17, v17, v24
    v_lshlrev_b32 v23, 16, v48
    v_and_b32 v24, 0xffff0000, v48
    v_fma_f32 v23, v23, s65, v16
    v_fma_f32 v24, v24, s65, v16
    v_exp_f32 v23, v23
    v_exp_f32 v24, v24
    s_nop 0
    v_add_f32 v13, v13, v23
    v_add_f32 v17, v17, v24
    v_lshlrev_b32 v23, 16, v49
    v_and_b32 v24, 0xffff0000, v49
    v_fma_f32 v23, v23, s65, v16
    v_fma_f32 v24, v24, s65, v16
    v_exp_f32 v23, v23
    v_exp_f32 v24, v24
    s_nop 0
    v_add_f32 v13, v13, v23
    v_add_f32 v17, v17, v24
    v_lshlrev_b32 v23, 16, v50
    v_and_b32 v24, 0xffff0000, v50
    v_fma_f32 v23, v23, s65, v16
    v_fma_f32 v24, v24, s65, v16
    v_exp_f32 v23, v23
    v_exp_f32 v24, v24
    s_nop 0
    v_add_f32 v13, v13, v23
    v_add_f32 v17, v17, v24
    v_lshlrev_b32 v23, 16, v51
    v_and_b32 v24, 0xffff0000, v51
    v_fma_f32 v23, v23, s65, v16
    v_fma_f32 v24, v24, s65, v16
    v_exp_f32 v23, v23
    v_exp_f32 v24, v24
    s_nop 0
    v_add_f32 v13, v13, v23
    v_add_f32 v17, v17, v24
    v_lshlrev_b32 v23, 16, v52
    v_and_b32 v24, 0xffff0000, v52
    v_fma_f32 v23, v23, s65, v16
    v_fma_f32 v24, v24, s65, v16
    v_exp_f32 v23, v23
    v_exp_f32 v24, v24
    s_nop 0
    v_add_f32 v13, v13, v23
    v_add_f32 v17, v17, v24
    v_lshlrev_b32 v23, 16, v53
    v_and_b32 v24, 0xffff0000, v53
    v_fma_f32 v23, v23, s65, v16
    v_fma_f32 v24, v24, s65, v16
    v_exp_f32 v23, v23
    v_exp_f32 v24, v24
    s_nop 0
    v_add_f32 v13, v13, v23
    v_add_f32 v17, v17, v24
    v_lshlrev_b32 v23, 16, v54
    v_and_b32 v24, 0xffff0000, v54
    v_fma_f32 v23, v23, s65, v16
    v_fma_f32 v24, v24, s65, v16
    v_exp_f32 v23, v23
    v_exp_f32 v24, v24
    s_nop 0
    v_add_f32 v13, v13, v23
    v_add_f32 v17, v17, v24
    v_lshlrev_b32 v23, 16, v55
    v_and_b32 v24, 0xffff0000, v55
    v_fma_f32 v23, v23, s65, v16
    v_fma_f32 v24, v24, s65, v16
    v_exp_f32 v23, v23
    v_exp_f32 v24, v24
    s_nop 0
    v_add_f32 v13, v13, v23
    v_add_f32 v17, v17, v24
    v_lshlrev_b32 v23, 16, v56
    v_and_b32 v24, 0xffff0000, v56
    v_fma_f32 v23, v23, s65, v16
    v_fma_f32 v24, v24, s65, v16
    v_exp_f32 v23, v23
    v_exp_f32 v24, v24
    s_nop 0
    v_add_f32 v13, v13, v23
    v_add_f32 v17, v17, v24
    v_lshlrev_b32 v23, 16, v57
    v_and_b32 v24, 0xffff0000, v57
    v_fma_f32 v23, v23, s65, v16
    v_fma_f32 v24, v24, s65, v16
    v_exp_f32 v23, v23
    v_exp_f32 v24, v24
    s_nop 0
    v_add_f32 v13, v13, v23
    v_add_f32 v17, v17, v24
    v_lshlrev_b32 v23, 16, v58
    v_and_b32 v24, 0xffff0000, v58
    v_fma_f32 v23, v23, s65, v16
    v_fma_f32 v24, v24, s65, v16
    v_exp_f32 v23, v23
    v_exp_f32 v24, v24
    s_nop 0
    v_add_f32 v13, v13, v23
    v_add_f32 v17, v17, v24
    v_lshlrev_b32 v23, 16, v59
    v_and_b32 v24, 0xffff0000, v59
    v_fma_f32 v23, v23, s65, v16
    v_fma_f32 v24, v24, s65, v16
    v_exp_f32 v23, v23
    v_exp_f32 v24, v24
    s_nop 0
    v_add_f32 v13, v13, v23
    v_add_f32 v17, v17, v24
    v_lshlrev_b32 v23, 16, v60
    v_and_b32 v24, 0xffff0000, v60
    v_fma_f32 v23, v23, s65, v16
    v_fma_f32 v24, v24, s65, v16
    v_exp_f32 v23, v23
    v_exp_f32 v24, v24
    s_nop 0
    v_add_f32 v13, v13, v23
    v_add_f32 v17, v17, v24
    v_lshlrev_b32 v23, 16, v61
    v_and_b32 v24, 0xffff0000, v61
    v_fma_f32 v23, v23, s65, v16
    v_fma_f32 v24, v24, s65, v16
    v_exp_f32 v23, v23
    v_exp_f32 v24, v24
    s_nop 0
    v_add_f32 v13, v13, v23
    v_add_f32 v17, v17, v24
    v_lshlrev_b32 v23, 16, v62
    v_and_b32 v24, 0xffff0000, v62
    v_fma_f32 v23, v23, s65, v16
    v_fma_f32 v24, v24, s65, v16
    v_exp_f32 v23, v23
    v_exp_f32 v24, v24
    s_nop 0
    v_add_f32 v13, v13, v23
    v_add_f32 v17, v17, v24
    v_lshlrev_b32 v23, 16, v63
    v_and_b32 v24, 0xffff0000, v63
    v_fma_f32 v23, v23, s65, v16
    v_fma_f32 v24, v24, s65, v16
    v_exp_f32 v23, v23
    v_exp_f32 v24, v24
    s_nop 0
    v_add_f32 v13, v13, v23
    v_add_f32 v17, v17, v24
    v_add_f32 v13, v13, v17
    s_nop 1
    v_add_f32_dpp v13, v13, v13 row_ror:2 row_mask:0xf bank_mask:0xf
    s_nop 1
    v_add_f32_dpp v13, v13, v13 row_ror:4 row_mask:0xf bank_mask:0xf
    s_nop 1
    v_add_f32_dpp v13, v13, v13 row_ror:8 row_mask:0xf bank_mask:0xf
    v_mov_b32 v23, v13
    s_nop 1
    v_permlane16_swap_b32 v13, v23
    v_add_f32 v13, v13, v23
    v_mov_b32 v23, v13
    s_nop 1
    v_permlane32_swap_b32 v13, v23
    v_add_f32 v13, v13, v23
    s_nop 1
    v_mov_b32_dpp v14, v12 quad_perm:[1,1,3,3] row_mask:0xf bank_mask:0xf
    v_mov_b32_dpp v15, v13 quad_perm:[1,1,3,3] row_mask:0xf bank_mask:0xf
    v_mov_b32 v18, v12
    v_bfi_b32 v12, v220, s72, v12
    v_bfi_b32 v13, v220, s73, v13
    v_bfi_b32 v14, v220, s76, v14
    v_bfi_b32 v15, v220, s77, v15
    s_lshl_b32 s63, s2, 4
    s_add_u32 s63, s63, 32768
    v_mov_b32 v20, 0
    s_mov_b64 exec, 1
    s_waitcnt vmcnt(0)
    buffer_store_dwordx4 v[12:15], v20, s[56:59], s63 offen sc1
    s_mov_b64 exec, -1
    v_xor_b32 v20, s72, v88
    v_bitop3_b32 v20, v89, s73, v20 bitop3:0xbe
    v_bitop3_b32 v20, v90, s76, v20 bitop3:0xbe
    v_bitop3_b32 v20, v91, s77, v20 bitop3:0xbe
    v_and_b32 v20, 0xff, v20
    v_cmp_eq_u32 vcc, 0, v20
    s_bcnt1_i32_b32 s4, vcc_lo
    s_cmp_ge_u32 s4, 26
    s_cselect_b32 s4, 1, 0
    v_mov_b32 v20, 157808
    v_mov_b32 v21, s4
    ds_write_b32 v20, v21
    s_mov_b32 s44, s24
    s_mov_b32 s45, s25
    s_mov_b32 s46, 0x380000
    s_mov_b32 s47, 0x20000
    s_mul_i32 s63, s66, 28672
    s_mul_i32 s64, s67, 448
    s_add_u32 s63, s63, s64
    v_lshrrev_b32 v20, 4, v2
    v_and_b32 v21, 1, v2
    v_lshl_add_u32 v20, v21, 2, v20
    v_lshlrev_b32 v223, 1, v20
    s_sub_u32 s63, s2, 200
    s_lshl_b32 s63, s63, 4
    v_add_u32 v223, s63, v223
    s_cmp_lt_u32 s2, 200
    s_cbranch_scc1 L_nofin132
    s_mov_b32 s52, s16
    s_mov_b32 s53, s17
    s_mov_b32 s54, 0x380
    s_mov_b32 s55, 0x20000
    buffer_load_ushort v221, v223, s[52:55], 0 offen
    s_mov_b32 s44, s34
    s_mov_b32 s45, s35
    s_mov_b32 s46, 0x380
    s_mov_b32 s47, 0x20000
    buffer_load_ushort v20, v223, s[44:47], 0 offen
    s_waitcnt vmcnt(0)
    v_lshlrev_b32 v221, 16, v221
    v_lshlrev_b32 v226, 16, v20
    v_add_f32 v221, v221, v226
L_nofin132:
    s_sleep 100
    s_lshr_b32 s63, s2, 5
    s_lshl_b32 s63, s63, 9
    s_add_u32 s63, s63, 32768
    v_lshlrev_b32 v4, 4, v7
    s_mov_b64 s[4:5], -1
    s_mov_b32 s64, 0
    s_mov_b32 s14, 999
L_poll133:
    s_mov_b64 exec, s[4:5]
    s_cbranch_execz L_sk136
    buffer_load_dwordx4 v[32:35], v4, s[56:59], s63 offen offset:0 sc1
L_sk136:
    s_mov_b64 exec, -1
    s_add_u32 s64, s64, 1
L_pj135:
    s_waitcnt vmcnt(0)
    v_xor_b32 v20, s72, v32
    v_bitop3_b32 v20, v33, s73, v20 bitop3:0xbe
    v_bitop3_b32 v20, v34, s76, v20 bitop3:0xbe
    v_bitop3_b32 v20, v35, s77, v20 bitop3:0xbe
    v_and_b32 v20, 0xff, v20
    v_cmp_ne_u32 vcc, 0, v20
    s_and_b64 s[4:5], s[4:5], vcc
    s_cbranch_scc0 L_polld134
    s_sleep 100
    s_cmp_lt_u32 s64, 262144
    s_cbranch_scc1 L_poll133
L_polld134:
    v_and_b32 v20, 1, v2
    v_cmp_eq_u32 vcc, 1, v20
    s_nop 1
    v_cndmask_b32 v32, v32, v34, vcc
    v_cndmask_b32 v33, v33, v35, vcc
    v_and_b32 v32, 0xffff0000, v32
    v_and_b32 v33, s71, v33
    v_mov_b32 v21, v32
    s_nop 1
    v_max_f32_dpp v21, v21, v21 row_ror:2 row_mask:0xf bank_mask:0xf
    s_nop 1
    v_max_f32_dpp v21, v21, v21 row_ror:4 row_mask:0xf bank_mask:0xf
    s_nop 1
    v_max_f32_dpp v21, v21, v21 row_ror:8 row_mask:0xf bank_mask:0xf
    v_mov_b32 v22, v21
    s_nop 1
    v_permlane16_swap_b32 v21, v22
    v_max_f32 v21, v21, v22
    v_mov_b32 v22, v21
    s_nop 1
    v_permlane32_swap_b32 v21, v22
    v_max_f32 v21, v21, v22
    v_sub_f32 v22, v32, v21
    v_sub_f32 v23, v18, v21
    v_mul_f32 v22, s65, v22
    v_mul_f32 v23, s65, v23
    v_exp_f32 v22, v22
    v_exp_f32 v23, v23
    s_nop 0
    v_mul_f32 v22, v22, v33
    s_nop 1
    v_add_f32_dpp v22, v22, v22 row_ror:2 row_mask:0xf bank_mask:0xf
    s_nop 1
    v_add_f32_dpp v22, v22, v22 row_ror:4 row_mask:0xf bank_mask:0xf
    s_nop 1
    v_add_f32_dpp v22, v22, v22 row_ror:8 row_mask:0xf bank_mask:0xf
    v_mov_b32 v24, v22
    s_nop 1
    v_permlane16_swap_b32 v22, v24
    v_add_f32 v22, v22, v24
    v_mov_b32 v24, v22
    s_nop 1
    v_permlane32_swap_b32 v22, v24
    v_add_f32 v22, v22, v24
    v_rcp_f32 v24, v22
    s_nop 0
    v_fma_f32 v25, -v22, v24, 1.0
    v_fma_f32 v24, v25, v24, v24
    v_lshlrev_b32 v20, 2, v20
    v_add_u32 v20, 157760, v20
    v_mul_f32 v21, s65, v21
    v_sub_f32 v21, 0, v21
    ds_write_b32 v20, v24
    ds_write_b32 v20, v23 offset:8
    ds_write_b32 v20, v21 offset:16
    s_and_b32 s4, s2, 0xf8
    s_lshl_b32 s4, s4, 10
    s_add_u32 s4, s4, 2097152
    s_add_u32 s4, s4, 4096
    v_add_u32 v20, 139264, v3
    s_waitcnt vmcnt(0)
    v_mov_b32 v20, 157792
    v_mov_b32 v21, 1
    s_waitcnt lgkmcnt(0)
    ds_write_b32 v20, v21
    s_sub_u32 s64, s2, 200
    s_cmp_ge_u32 s64, 28
    s_cselect_b32 s68, 130176, 0
    s_cselect_b32 s63, 64640, 0
    s_mul_i32 s64, s64, 32
    s_add_u32 s68, s68, s64
    s_add_u32 s68, s68, 1048576
    s_add_u32 s63, s63, s64
    s_add_u32 s63, s63, 1572864
    v_lshlrev_b32 v227, 10, v7
    v_and_b32 v20, 1, v2
    v_lshl_add_u32 v227, v20, 4, v227
    v_add_u32 v228, 32768, v227
    v_add_u32 v229, 65536, v227
    v_add_u32 v230, 98304, v227
    v_mov_b32 v128, 0
    s_cmp_ge_u32 s66, 112
    s_cbranch_scc1 L_noh137
    s_mov_b32 s52, s30
    s_mov_b32 s53, s31
    s_mov_b32 s54, 0xe00
    s_mov_b32 s55, 0x20000
    v_and_b32 v20, 15, v2
    v_lshlrev_b32 v20, 1, v20
    s_lshl_b32 s69, s66, 5
    buffer_load_ushort v8, v20, s[52:55], s69 offen
    s_lshr_b32 s69, s66, 2
    s_lshl_b32 s69, s69, 11
    s_add_u32 s69, s69, 1835008
    v_mov_b32 v136, 0
    v_mov_b32 v137, 0
    v_mov_b32 v138, 0
    v_mov_b32 v139, 0
    s_mov_b64 s[4:5], -1
    s_mov_b32 s6, 0xffffffff
    s_mov_b32 s7, 0xffff
    s_mov_b32 s64, 0
    s_mov_b32 s14, 999
L_poll138:
    s_mov_b64 exec, s[4:5]
    s_cbranch_execz L_sk141
    buffer_load_dwordx4 v[132:135], v3, s[56:59], s69 offen offset:0 sc1
L_sk141:
    s_mov_b64 exec, s[6:7]
    s_cbranch_execz L_sk142
    buffer_load_dwordx4 v[136:139], v3, s[56:59], s69 offen offset:1024 sc1
L_sk142:
    s_mov_b64 exec, -1
    s_add_u32 s64, s64, 1
L_pj140:
    s_waitcnt vmcnt(0)
    v_xor_b32 v20, s72, v132
    v_bitop3_b32 v20, v133, s73, v20 bitop3:0xbe
    v_bitop3_b32 v20, v134, s76, v20 bitop3:0xbe
    v_bitop3_b32 v20, v135, s77, v20 bitop3:0xbe
    v_and_b32 v20, 0xff, v20
    v_xor_b32 v21, s72, v136
    v_bitop3_b32 v21, v137, s73, v21 bitop3:0xbe
    v_bitop3_b32 v21, v138, s76, v21 bitop3:0xbe
    v_bitop3_b32 v21, v139, s77, v21 bitop3:0xbe
    v_and_b32 v21, 0xff, v21
    v_cmp_ne_u32 vcc, 0, v20
    s_and_b64 s[4:5], s[4:5], vcc
    v_cmp_ne_u32 vcc, 0, v21
    s_and_b64 s[6:7], s[6:7], vcc
    s_or_b64 s[12:13], s[4:5], s[6:7]
    s_cbranch_scc0 L_polld139
    s_sleep 64
    s_cmp_lt_u32 s64, 262144
    s_cbranch_scc1 L_poll138
L_polld139:
    v_and_b32 v132, s71, v132
    v_and_b32 v133, s71, v133
    v_and_b32 v134, s71, v134
    v_and_b32 v135, s71, v135
    v_and_b32 v136, s71, v136
    v_and_b32 v137, s71, v137
    v_and_b32 v138, s71, v138
    v_and_b32 v139, s71, v139
    v_add_f32 v132, v132, v136
    v_add_f32 v133, v133, v137
    v_add_f32 v134, v134, v138
    v_add_f32 v135, v135, v139
    s_bitcmp1_b32 s66, 1
    s_cselect_b64 vcc, -1, 0
    s_nop 0
    v_cndmask_b32 v132, v132, v134, vcc
    v_cndmask_b32 v133, v133, v135, vcc
    s_bitcmp1_b32 s66, 0
    s_cselect_b64 vcc, -1, 0
    s_nop 0
    v_cndmask_b32 v12, v132, v133, vcc
    v_mov_b32 v20, v12
    s_nop 1
    v_permlane16_swap_b32 v12, v20
    v_add_f32 v12, v12, v20
    v_mov_b32 v20, v12
    s_nop 1
    v_permlane32_swap_b32 v12, v20
    v_add_f32 v12, v12, v20
    v_cvt_pk_bf16_f32 v12, v12, v12
    v_and_b32 v12, 0xffff0000, v12
    v_lshlrev_b32 v8, 16, v8
    v_add_f32 v12, v12, v8
    v_cvt_pk_bf16_f32 v12, v12, v12
    v_and_b32 v12, 0xffff0000, v12
    v_mul_f32 v13, v12, v12
    v_mul_f32 v13, v13, v12
    v_mov_b32 v14, 0x3d372713
    v_fma_f32 v13, v13, v14, v12
    v_mul_f32 v13, 0xc0135761, v13
    v_exp_f32 v13, v13
    s_nop 0
    v_add_f32 v13, 1.0, v13
    v_rcp_f32 v13, v13
    s_nop 0
    v_mul_f32 v12, v12, v13
    v_cvt_pk_bf16_f32 v12, v12, v12
    v_mov_b32 v128, v12
    s_nop 1
    v_mov_b32_dpp v128, v12 row_ror:15 row_mask:0x2 bank_mask:0xf
    v_mov_b32_dpp v128, v12 row_ror:14 row_mask:0x4 bank_mask:0xf
    v_mov_b32_dpp v128, v12 row_ror:13 row_mask:0x8 bank_mask:0xf
L_noh137:
    s_mov_b32 s52, s36
    s_mov_b32 s53, s37
    s_mov_b32 s54, 0x380
    s_mov_b32 s55, 0x20000
    v_bfe_u32 v20, v2, 3, 2
    v_lshlrev_b32 v20, 14, v20
    v_lshrrev_b32 v21, 5, v2
    v_lshl_add_u32 v20, v21, 11, v20
    v_and_b32 v21, 7, v2
    v_lshl_add_u32 v222, v21, 4, v20
    v_add_u32 v9, 4096, v222
    v_add_u32 v10, 8192, v222
    v_add_u32 v11, 12288, v222
    s_lshr_b32 s63, s2, 5
    s_lshl_b32 s63, s63, 16
    s_and_b32 s64, s66, 15
    s_lshl_b32 s64, s64, 7
    s_add_u32 s63, s63, s64
    s_add_u32 s63, s63, 65536
    buffer_load_dwordx4 v[40:43], v3, s[56:59], s62 offen sc1
    s_waitcnt vmcnt(0)
    s_mov_b32 s44, s24
    s_mov_b32 s45, s25
    s_mov_b32 s46, 0x380000
    s_mov_b32 s47, 0x20000
    s_mul_i32 s69, s66, 28672
    s_mul_i32 s4, s67, 448
    s_add_u32 s69, s69, s4
    s_mov_b32 s48, s32
    s_mov_b32 s49, s33
    s_mov_b32 s50, 0x188000
    s_mov_b32 s51, 0x20000
    s_mul_i32 s70, s66, 14336
    s_add_u32 s70, s70, s4
    s_waitcnt vmcnt(0) lgkmcnt(0)
    s_barrier
    buffer_load_dwordx4 v[64:67], v225, s[48:51], s70 offen nt
    s_mov_b32 exec_lo, 0x0fff0fff
    s_mov_b32 exec_hi, 0x0fff0fff
    buffer_load_dwordx4 v[68:71], v225, s[48:51], s70 offen offset:256 nt
    s_mov_b64 exec, -1
    s_add_u32 s70, s70, 3584
    buffer_load_dwordx4 v[72:75], v225, s[48:51], s70 offen nt
    s_mov_b32 exec_lo, 0x0fff0fff
    s_mov_b32 exec_hi, 0x0fff0fff
    buffer_load_dwordx4 v[76:79], v225, s[48:51], s70 offen offset:256 nt
    s_mov_b64 exec, -1
    s_add_u32 s70, s70, 3584
    buffer_load_dwordx4 v[80:83], v225, s[48:51], s70 offen nt
    s_mov_b32 exec_lo, 0x0fff0fff
    s_mov_b32 exec_hi, 0x0fff0fff
    buffer_load_dwordx4 v[84:87], v225, s[48:51], s70 offen offset:256 nt
    s_mov_b64 exec, -1
    s_add_u32 s70, s70, 3584
    buffer_load_dwordx4 v[88:91], v225, s[48:51], s70 offen nt
    s_mov_b32 exec_lo, 0x0fff0fff
    s_mov_b32 exec_hi, 0x0fff0fff
    buffer_load_dwordx4 v[92:95], v225, s[48:51], s70 offen offset:256 nt
    s_mov_b64 exec, -1
    s_add_u32 s70, s70, 3584
    buffer_load_dwordx4 v[144:147], v225, s[44:47], s69 offen nt
    s_mov_b32 exec_lo, 0x0fff0fff
    s_mov_b32 exec_hi, 0x0fff0fff
    buffer_load_dwordx4 v[148:151], v225, s[44:47], s69 offen offset:256 nt
    s_mov_b64 exec, -1
    s_add_u32 s69, s69, 3584
    buffer_load_dwordx4 v[152:155], v225, s[44:47], s69 offen nt
    s_mov_b32 exec_lo, 0x0fff0fff
    s_mov_b32 exec_hi, 0x0fff0fff
    buffer_load_dwordx4 v[156:159], v225, s[44:47], s69 offen offset:256 nt
    s_mov_b64 exec, -1
    s_add_u32 s69, s69, 3584
    buffer_load_dwordx4 v[160:163], v225, s[44:47], s69 offen nt
    s_mov_b32 exec_lo, 0x0fff0fff
    s_mov_b32 exec_hi, 0x0fff0fff
    buffer_load_dwordx4 v[164:167], v225, s[44:47], s69 offen offset:256 nt
    s_mov_b64 exec, -1
    s_add_u32 s69, s69, 3584
    buffer_load_dwordx4 v[168:171], v225, s[44:47], s69 offen nt
    s_mov_b32 exec_lo, 0x0fff0fff
    s_mov_b32 exec_hi, 0x0fff0fff
    buffer_load_dwordx4 v[172:175], v225, s[44:47], s69 offen offset:256 nt
    s_mov_b64 exec, -1
    s_add_u32 s69, s69, 3584
    buffer_load_dwordx4 v[176:179], v225, s[44:47], s69 offen nt
    s_mov_b32 exec_lo, 0x0fff0fff
    s_mov_b32 exec_hi, 0x0fff0fff
    buffer_load_dwordx4 v[180:183], v225, s[44:47], s69 offen offset:256 nt
    s_mov_b64 exec, -1
    s_add_u32 s69, s69, 3584
    buffer_load_dwordx4 v[184:187], v225, s[44:47], s69 offen nt
    s_mov_b32 exec_lo, 0x0fff0fff
    s_mov_b32 exec_hi, 0x0fff0fff
    buffer_load_dwordx4 v[188:191], v225, s[44:47], s69 offen offset:256 nt
    s_mov_b64 exec, -1
    s_add_u32 s69, s69, 3584
    buffer_load_dwordx4 v[192:195], v225, s[44:47], s69 offen nt
    s_mov_b32 exec_lo, 0x0fff0fff
    s_mov_b32 exec_hi, 0x0fff0fff
    buffer_load_dwordx4 v[196:199], v225, s[44:47], s69 offen offset:256 nt
    s_mov_b64 exec, -1
    s_add_u32 s69, s69, 3584
    buffer_load_dwordx4 v[200:203], v225, s[44:47], s69 offen nt
    s_mov_b32 exec_lo, 0x0fff0fff
    s_mov_b32 exec_hi, 0x0fff0fff
    buffer_load_dwordx4 v[204:207], v225, s[44:47], s69 offen offset:256 nt
    s_mov_b64 exec, -1
    s_add_u32 s69, s69, 3584
    s_waitcnt vmcnt(16)
    v_and_b32_dpp v96, v128, v216 row_newbcast:0 row_mask:0xf bank_mask:0xf
    v_and_b32_dpp v97, v128, v217 row_newbcast:0 row_mask:0xf bank_mask:0xf
    v_and_b32_dpp v98, v128, v218 row_newbcast:0 row_mask:0xf bank_mask:0xf
    v_and_b32_dpp v99, v128, v219 row_newbcast:0 row_mask:0xf bank_mask:0xf
    v_and_b32_dpp v100, v128, v216 row_newbcast:4 row_mask:0xf bank_mask:0xf
    v_and_b32_dpp v101, v128, v217 row_newbcast:4 row_mask:0xf bank_mask:0xf
    v_and_b32_dpp v102, v128, v218 row_newbcast:4 row_mask:0xf bank_mask:0xf
    v_and_b32_dpp v103, v128, v219 row_newbcast:4 row_mask:0xf bank_mask:0xf
    v_mfma_f32_16x16x32_bf16 v[208:211], v[96:99], v[64:67], v[208:211]
    v_mfma_f32_16x16x32_bf16 v[212:215], v[96:99], v[68:71], v[212:215]
    v_and_b32_dpp v104, v128, v216 row_newbcast:8 row_mask:0xf bank_mask:0xf
    v_and_b32_dpp v105, v128, v217 row_newbcast:8 row_mask:0xf bank_mask:0xf
    v_and_b32_dpp v106, v128, v218 row_newbcast:8 row_mask:0xf bank_mask:0xf
    v_and_b32_dpp v107, v128, v219 row_newbcast:8 row_mask:0xf bank_mask:0xf
    v_mfma_f32_16x16x32_bf16 v[208:211], v[100:103], v[72:75], v[208:211]
    v_mfma_f32_16x16x32_bf16 v[212:215], v[100:103], v[76:79], v[212:215]
    v_and_b32_dpp v108, v128, v216 row_newbcast:12 row_mask:0xf bank_mask:0xf
    v_and_b32_dpp v109, v128, v217 row_newbcast:12 row_mask:0xf bank_mask:0xf
    v_and_b32_dpp v110, v128, v218 row_newbcast:12 row_mask:0xf bank_mask:0xf
    v_and_b32_dpp v111, v128, v219 row_newbcast:12 row_mask:0xf bank_mask:0xf
    v_mfma_f32_16x16x32_bf16 v[208:211], v[104:107], v[80:83], v[208:211]
    v_mfma_f32_16x16x32_bf16 v[212:215], v[104:107], v[84:87], v[212:215]
    v_mfma_f32_16x16x32_bf16 v[208:211], v[108:111], v[88:91], v[208:211]
    v_mfma_f32_16x16x32_bf16 v[212:215], v[108:111], v[92:95], v[212:215]
    s_mov_b64 s[4:5], -1
    s_mov_b64 s[6:7], -1
    s_mov_b64 s[8:9], -1
    s_mov_b64 s[10:11], -1
    s_mov_b32 s64, 0
    s_mov_b32 s14, 999
L_poll145:
    s_mov_b64 exec, s[4:5]
    s_cbranch_execz L_sk148
    buffer_load_dwordx4 v[32:35], v222, s[56:59], s63 offen offset:0 sc1
L_sk148:
    s_mov_b64 exec, s[6:7]
    s_cbranch_execz L_sk149
    buffer_load_dwordx4 v[36:39], v9, s[56:59], s63 offen offset:0 sc1
L_sk149:
    s_mov_b64 exec, s[8:9]
    s_cbranch_execz L_sk150
    buffer_load_dwordx4 v[40:43], v10, s[56:59], s63 offen offset:0 sc1
L_sk150:
    s_mov_b64 exec, s[10:11]
    s_cbranch_execz L_sk151
    buffer_load_dwordx4 v[44:47], v11, s[56:59], s63 offen offset:0 sc1
L_sk151:
    s_mov_b64 exec, -1
    s_add_u32 s64, s64, 1
L_pj147:
    s_waitcnt vmcnt(0)
    v_max3_u32 v20, v32, v33, v34
    v_max_u32 v20, v20, v35
    v_max3_u32 v21, v36, v37, v38
    v_max_u32 v21, v21, v39
    v_max3_u32 v22, v40, v41, v42
    v_max_u32 v22, v22, v43
    v_max3_u32 v23, v44, v45, v46
    v_max_u32 v23, v23, v47
    v_cmp_eq_u32 vcc, -1, v20
    s_and_b64 s[4:5], s[4:5], vcc
    v_cmp_eq_u32 vcc, -1, v21
    s_and_b64 s[6:7], s[6:7], vcc
    v_cmp_eq_u32 vcc, -1, v22
    s_and_b64 s[8:9], s[8:9], vcc
    v_cmp_eq_u32 vcc, -1, v23
    s_and_b64 s[10:11], s[10:11], vcc
    s_or_b64 s[12:13], s[4:5], s[6:7]
    s_or_b64 s[12:13], s[12:13], s[8:9]
    s_or_b64 s[12:13], s[12:13], s[10:11]
    s_cbranch_scc0 L_polld146
    s_cmp_lt_u32 s64, 262144
    s_cbranch_scc1 L_poll145
L_polld146:
    v_add_f32 v12, v32, v36
    v_add_f32 v16, v40, v44
    v_add_f32 v13, v33, v37
    v_add_f32 v17, v41, v45
    v_add_f32 v14, v34, v38
    v_add_f32 v18, v42, v46
    v_add_f32 v15, v35, v39
    v_add_f32 v19, v43, v47
    v_add_f32 v12, v12, v16
    v_add_f32 v13, v13, v17
    v_add_f32 v14, v14, v18
    v_add_f32 v15, v15, v19
    s_nop 1
    v_permlane32_swap_b32 v12, v14
    v_permlane32_swap_b32 v13, v15
    v_add_f32 v12, v12, v14
    v_add_f32 v13, v13, v15
    s_nop 1
    v_permlane16_swap_b32 v12, v13
    v_add_f32 v12, v12, v13
    s_nop 1
    v_add_f32_dpp v12, v12, v12 row_ror:8 row_mask:0xf bank_mask:0xf
    v_cvt_pk_bf16_f32 v12, v12, v12
    s_nop 1
    v_and_b32_dpp v96, v12, v216 row_newbcast:0 row_mask:0xf bank_mask:0xf
    v_and_b32_dpp v97, v12, v217 row_newbcast:0 row_mask:0xf bank_mask:0xf
    v_and_b32_dpp v98, v12, v218 row_newbcast:0 row_mask:0xf bank_mask:0xf
    v_and_b32_dpp v99, v12, v219 row_newbcast:0 row_mask:0xf bank_mask:0xf
    v_and_b32_dpp v100, v12, v216 row_newbcast:1 row_mask:0xf bank_mask:0xf
    v_and_b32_dpp v101, v12, v217 row_newbcast:1 row_mask:0xf bank_mask:0xf
    v_and_b32_dpp v102, v12, v218 row_newbcast:1 row_mask:0xf bank_mask:0xf
    v_and_b32_dpp v103, v12, v219 row_newbcast:1 row_mask:0xf bank_mask:0xf
    v_mfma_f32_16x16x32_bf16 v[208:211], v[96:99], v[144:147], v[208:211]
    v_mfma_f32_16x16x32_bf16 v[212:215], v[96:99], v[148:151], v[212:215]
    v_and_b32_dpp v104, v12, v216 row_newbcast:2 row_mask:0xf bank_mask:0xf
    v_and_b32_dpp v105, v12, v217 row_newbcast:2 row_mask:0xf bank_mask:0xf
    v_and_b32_dpp v106, v12, v218 row_newbcast:2 row_mask:0xf bank_mask:0xf
    v_and_b32_dpp v107, v12, v219 row_newbcast:2 row_mask:0xf bank_mask:0xf
    v_mfma_f32_16x16x32_bf16 v[208:211], v[100:103], v[152:155], v[208:211]
    v_mfma_f32_16x16x32_bf16 v[212:215], v[100:103], v[156:159], v[212:215]
    v_and_b32_dpp v108, v12, v216 row_newbcast:3 row_mask:0xf bank_mask:0xf
    v_and_b32_dpp v109, v12, v217 row_newbcast:3 row_mask:0xf bank_mask:0xf
    v_and_b32_dpp v110, v12, v218 row_newbcast:3 row_mask:0xf bank_mask:0xf
    v_and_b32_dpp v111, v12, v219 row_newbcast:3 row_mask:0xf bank_mask:0xf
    v_mfma_f32_16x16x32_bf16 v[208:211], v[104:107], v[160:163], v[208:211]
    v_mfma_f32_16x16x32_bf16 v[212:215], v[104:107], v[164:167], v[212:215]
    v_and_b32_dpp v112, v12, v216 row_newbcast:4 row_mask:0xf bank_mask:0xf
    v_and_b32_dpp v113, v12, v217 row_newbcast:4 row_mask:0xf bank_mask:0xf
    v_and_b32_dpp v114, v12, v218 row_newbcast:4 row_mask:0xf bank_mask:0xf
    v_and_b32_dpp v115, v12, v219 row_newbcast:4 row_mask:0xf bank_mask:0xf
    v_mfma_f32_16x16x32_bf16 v[208:211], v[108:111], v[168:171], v[208:211]
    v_mfma_f32_16x16x32_bf16 v[212:215], v[108:111], v[172:175], v[212:215]
    v_and_b32_dpp v116, v12, v216 row_newbcast:5 row_mask:0xf bank_mask:0xf
    v_and_b32_dpp v117, v12, v217 row_newbcast:5 row_mask:0xf bank_mask:0xf
    v_and_b32_dpp v118, v12, v218 row_newbcast:5 row_mask:0xf bank_mask:0xf
    v_and_b32_dpp v119, v12, v219 row_newbcast:5 row_mask:0xf bank_mask:0xf
    v_mfma_f32_16x16x32_bf16 v[208:211], v[112:115], v[176:179], v[208:211]
    v_mfma_f32_16x16x32_bf16 v[212:215], v[112:115], v[180:183], v[212:215]
    v_and_b32_dpp v120, v12, v216 row_newbcast:6 row_mask:0xf bank_mask:0xf
    v_and_b32_dpp v121, v12, v217 row_newbcast:6 row_mask:0xf bank_mask:0xf
    v_and_b32_dpp v122, v12, v218 row_newbcast:6 row_mask:0xf bank_mask:0xf
    v_and_b32_dpp v123, v12, v219 row_newbcast:6 row_mask:0xf bank_mask:0xf
    v_mfma_f32_16x16x32_bf16 v[208:211], v[116:119], v[184:187], v[208:211]
    v_mfma_f32_16x16x32_bf16 v[212:215], v[116:119], v[188:191], v[212:215]
    v_and_b32_dpp v124, v12, v216 row_newbcast:7 row_mask:0xf bank_mask:0xf
    v_and_b32_dpp v125, v12, v217 row_newbcast:7 row_mask:0xf bank_mask:0xf
    v_and_b32_dpp v126, v12, v218 row_newbcast:7 row_mask:0xf bank_mask:0xf
    v_and_b32_dpp v127, v12, v219 row_newbcast:7 row_mask:0xf bank_mask:0xf
    v_mfma_f32_16x16x32_bf16 v[208:211], v[120:123], v[192:195], v[208:211]
    v_mfma_f32_16x16x32_bf16 v[212:215], v[120:123], v[196:199], v[212:215]
    v_mfma_f32_16x16x32_bf16 v[208:211], v[124:127], v[200:203], v[208:211]
    v_mfma_f32_16x16x32_bf16 v[212:215], v[124:127], v[204:207], v[212:215]
    s_nop 7
    v_permlane32_swap_b32 v208, v212
    v_permlane32_swap_b32 v209, v213
    v_permlane32_swap_b32 v210, v214
    v_permlane32_swap_b32 v211, v215
    v_bfi_b32 v208, v220, s72, v208
    v_bfi_b32 v209, v220, s73, v209
    v_bfi_b32 v210, v220, s76, v210
    v_bfi_b32 v211, v220, s77, v211
    s_mov_b32 exec_hi, 0x0fff0fff
    buffer_store_dwordx4 v[208:211], v224, s[56:59], s62 offen sc1
    s_mov_b32 exec_hi, -1
    s_cmp_lt_u32 s2, 200
    s_cbranch_scc1 L_end123
    s_waitcnt vmcnt(0)
    s_mov_b64 s[4:5], -1
    s_mov_b64 s[6:7], -1
    s_mov_b64 s[8:9], -1
    s_mov_b64 s[10:11], -1
    s_mov_b32 s64, 0
    s_mov_b32 s14, 999
L_poll152:
    s_mov_b64 exec, s[4:5]
    s_cbranch_execz L_sk155
    buffer_load_dwordx4 v[48:51], v227, s[56:59], s68 offen offset:0 sc1
L_sk155:
    s_mov_b64 exec, s[6:7]
    s_cbranch_execz L_sk156
    buffer_load_dwordx4 v[52:55], v228, s[56:59], s68 offen offset:0 sc1
L_sk156:
    s_mov_b64 exec, s[8:9]
    s_cbranch_execz L_sk157
    buffer_load_dwordx4 v[56:59], v229, s[56:59], s68 offen offset:0 sc1
L_sk157:
    s_mov_b64 exec, s[10:11]
    s_cbranch_execz L_sk158
    buffer_load_dwordx4 v[60:63], v230, s[56:59], s68 offen offset:0 sc1
L_sk158:
    s_mov_b64 exec, -1
    s_add_u32 s64, s64, 1
L_pj154:
    s_waitcnt vmcnt(0)
    v_xor_b32 v20, s72, v48
    v_bitop3_b32 v20, v49, s73, v20 bitop3:0xbe
    v_bitop3_b32 v20, v50, s76, v20 bitop3:0xbe
    v_bitop3_b32 v20, v51, s77, v20 bitop3:0xbe
    v_and_b32 v20, 0xff, v20
    v_xor_b32 v21, s72, v52
    v_bitop3_b32 v21, v53, s73, v21 bitop3:0xbe
    v_bitop3_b32 v21, v54, s76, v21 bitop3:0xbe
    v_bitop3_b32 v21, v55, s77, v21 bitop3:0xbe
    v_and_b32 v21, 0xff, v21
    v_xor_b32 v22, s72, v56
    v_bitop3_b32 v22, v57, s73, v22 bitop3:0xbe
    v_bitop3_b32 v22, v58, s76, v22 bitop3:0xbe
    v_bitop3_b32 v22, v59, s77, v22 bitop3:0xbe
    v_and_b32 v22, 0xff, v22
    v_xor_b32 v23, s72, v60
    v_bitop3_b32 v23, v61, s73, v23 bitop3:0xbe
    v_bitop3_b32 v23, v62, s76, v23 bitop3:0xbe
    v_bitop3_b32 v23, v63, s77, v23 bitop3:0xbe
    v_and_b32 v23, 0xff, v23
    v_cmp_ne_u32 vcc, 0, v20
    s_and_b64 s[4:5], s[4:5], vcc
    v_cmp_ne_u32 vcc, 0, v21
    s_and_b64 s[6:7], s[6:7], vcc
    v_cmp_ne_u32 vcc, 0, v22
    s_and_b64 s[8:9], s[8:9], vcc
    v_cmp_ne_u32 vcc, 0, v23
    s_and_b64 s[10:11], s[10:11], vcc
    s_or_b64 s[12:13], s[4:5], s[6:7]
    s_or_b64 s[12:13], s[12:13], s[8:9]
    s_or_b64 s[12:13], s[12:13], s[10:11]
    s_cbranch_scc0 L_polld153
    s_cmp_lt_u32 s64, 262144
    s_cbranch_scc1 L_poll152
L_polld153:
    v_and_b32 v48, s71, v48
    v_and_b32 v49, s71, v49
    v_and_b32 v50, s71, v50
    v_and_b32 v51, s71, v51
    v_and_b32 v52, s71, v52
    v_and_b32 v53, s71, v53
    v_and_b32 v54, s71, v54
    v_and_b32 v55, s71, v55
    v_and_b32 v56, s71, v56
    v_and_b32 v57, s71, v57
    v_and_b32 v58, s71, v58
    v_and_b32 v59, s71, v59
    v_and_b32 v60, s71, v60
    v_and_b32 v61, s71, v61
    v_and_b32 v62, s71, v62
    v_and_b32 v63, s71, v63
    v_add_f32 v12, v48, v52
    v_add_f32 v16, v56, v60
    v_add_f32 v13, v49, v53
    v_add_f32 v17, v57, v61
    v_add_f32 v14, v50, v54
    v_add_f32 v18, v58, v62
    v_add_f32 v15, v51, v55
    v_add_f32 v19, v59, v63
    v_add_f32 v12, v12, v16
    v_add_f32 v13, v13, v17
    v_add_f32 v14, v14, v18
    v_add_f32 v15, v15, v19
    s_nop 1
    v_permlane32_swap_b32 v12, v14
    v_permlane32_swap_b32 v13, v15
    v_add_f32 v12, v12, v14
    v_add_f32 v13, v13, v15
    s_nop 1
    v_permlane16_swap_b32 v12, v13
    v_add_f32 v12, v12, v13
    s_nop 1
    v_add_f32_dpp v12, v12, v12 row_ror:2 row_mask:0xf bank_mask:0xf
    s_nop 1
    v_add_f32_dpp v12, v12, v12 row_ror:4 row_mask:0xf bank_mask:0xf
    s_nop 1
    v_add_f32_dpp v12, v12, v12 row_ror:8 row_mask:0xf bank_mask:0xf
    v_add_f32 v12, v221, v12
    v_cvt_pk_bf16_f32 v12, v12, v12
    s_mov_b32 exec_lo, 0x00030003
    s_mov_b32 exec_hi, 0x00030003
    buffer_store_short v12, v223, s[52:55], 0 offen
    s_cmp_lg_u32 s2, 255
    s_cbranch_scc1 L_end123
    s_mov_b64 exec, 1
    s_add_u32 s60, s60, 1
    v_mov_b32 v21, s60
    v_mov_b32 v22, 0
    buffer_store_dword v21, v22, s[56:59], 0 offen sc1
L_end123:
L_done:
    s_endpgm
.section .rodata,"a"
.p2align 6
.amdhsa_kernel parallel_sum__gqa_block_cached__dense_activation_gelu__decode_kernel
  .amdhsa_next_free_vgpr 232
  .amdhsa_next_free_sgpr 96
  .amdhsa_accum_offset 232
  .amdhsa_group_segment_fixed_size 0
  .amdhsa_kernarg_size 104
  .amdhsa_user_sgpr_count 2
  .amdhsa_user_sgpr_kernarg_segment_ptr 1
  .amdhsa_system_sgpr_workgroup_id_x 1
  .amdhsa_float_denorm_mode_32 3
.end_amdhsa_kernel
```
